```python
import torch

def _softmax(x, axis=-1):
    return torch.softmax(x, dim=axis)
def _gelu(x):
    return torch.nn.functional.gelu(x, approximate="tanh")
def _silu(x):
    return torch.nn.functional.silu(x)
def _sigmoid(x):
    return torch.sigmoid(x)
def _layernorm(x, axis=-1, eps=1e-5):
    m = x.mean(dim=axis, keepdim=True)
    v = x.var(dim=axis, keepdim=True, unbiased=False)
    return (x - m) / torch.sqrt(v + eps)
def _scatter_add(tgt, idx, src, axis=0):
    return tgt.clone().index_add_(axis, idx, src)
def _segment_sum(src, seg, n):
    out = torch.zeros((n,) + src.shape[1:], dtype=src.dtype)
    return out.index_add_(0, seg, src)
def _pad(x, pw):
    flat = tuple(v for pair in reversed(pw) for v in pair)
    return torch.nn.functional.pad(x, flat)

kernel_name = 'sequential_preLN__linear_kernel_hedgehog__glu_gated_geglu__prompt'

def setup_inputs():

    _w = (lambda a: (lambda t: t.to(torch.bfloat16) if t.is_floating_point() else t)(torch.as_tensor(a)))
    def _A_setup():
        B, S, D, H = 1, 2048, 640, 32
        Dh = D // H
        return {
            "x": _w((lambda *s: torch.randn(*s, dtype=torch.bfloat16) * 0.05)(B, S, D)),
            "wqkv": _w((lambda *s: torch.randn(*s, dtype=torch.bfloat16) * 0.2)(D, 3 * D)),
            "w_phi": _w((lambda *s: torch.randn(*s, dtype=torch.bfloat16) * 0.2)(H, Dh, Dh) * (Dh ** -0.5)),
            "wo": _w((lambda *s: torch.randn(*s, dtype=torch.bfloat16) * 0.05)(D, D)),
        }
    _A_in = _A_setup()

    def _B_setup():
        B, S, Dm, Df = 1, 2048, 640, 1536
        return {
            "x": _w((lambda *s: torch.randn(*s, dtype=torch.bfloat16) * 0.05)(B, S, Dm)),
            "w_gate": _w((lambda *s: torch.randn(*s, dtype=torch.bfloat16) * 0.4)(Dm, Df) * (Dm ** -0.5)),
            "w_up": _w((lambda *s: torch.randn(*s, dtype=torch.bfloat16) * 0.4)(Dm, Df) * (Dm ** -0.5)),
            "w_down": _w((lambda *s: torch.randn(*s, dtype=torch.bfloat16) * 0.4)(Df, Dm) * (Df ** -0.5)),
        }
    _B_in = _B_setup()

    return {
        "A_x": _A_in["x"],
        "A_wqkv": _A_in["wqkv"],
        "A_w_phi": _A_in["w_phi"],
        "A_wo": _A_in["wo"],
        "B_x": _B_in["x"],
        "B_w_gate": _B_in["w_gate"],
        "B_w_up": _B_in["w_up"],
        "B_w_down": _B_in["w_down"],
    }

def reference(A_x, A_wqkv, A_w_phi, A_wo, B_x, B_w_gate, B_w_up, B_w_down):
    def _A_ref(x, wqkv, w_phi, wo):
        B, S, D = x.shape
        H = 32; Dh = D // H
        qkv = (lambda x, *d: x.permute(*d))((x @ wqkv).reshape(B, S, 3, H, Dh), 2, 0, 3, 1, 4)
        q, k, v = qkv[0], qkv[1], qkv[2]
        pq = torch.einsum("bhsd,hdf->bhsf", q, w_phi)
        pk = torch.einsum("bhsd,hdf->bhsf", k, w_phi)
        phi_q = torch.concatenate([_softmax(pq, axis=-1), _softmax(-pq, axis=-1)], axis=-1)
        phi_k = torch.concatenate([_softmax(pk, axis=-1), _softmax(-pk, axis=-1)], axis=-1)
        kv = torch.einsum("bhsf,bhsd->bhfd", phi_k, v)
        z  = torch.einsum("bhsf->bhf", phi_k)
        num = torch.einsum("bhqf,bhfd->bhqd", phi_q, kv)
        den = torch.einsum("bhqf,bhf->bhq", phi_q, z)[..., None] + 1e-6
        o = num / den
        return (lambda x, *d: x.permute(*d))(o, 0, 2, 1, 3).reshape(B, S, D) @ wo

    def _B_ref(x, w_gate, w_up, w_down):
        g = torch.einsum("bsd,df->bsf", x, w_gate)
        u = torch.einsum("bsd,df->bsf", x, w_up)
        h = _gelu(g) * u
        return torch.einsum("bsf,fd->bsd", h, w_down)

    x = A_x
    h = x + _A_ref(_layernorm(x, axis=-1), A_wqkv, A_w_phi, A_wo)
    h2 = h + _B_ref(_layernorm(h, axis=-1), B_w_gate, B_w_up, B_w_down)
    return h2
```

```asm
; @launch grid=(256,1,1) block=(256,1,1) lds=163840
.amdgcn_target "amdgcn-amd-amdhsa--gfx950"
.text
.globl sequential_preLN__linear_kernel_hedgehog__glu_gated_geglu__prompt_kernel
.p2align 8
.type sequential_preLN__linear_kernel_hedgehog__glu_gated_geglu__prompt_kernel,@function
sequential_preLN__linear_kernel_hedgehog__glu_gated_geglu__prompt_kernel:
    s_load_dwordx16 s[4:19], s[0:1], 0
    s_load_dwordx4 s[20:23], s[0:1], 64
    s_load_dwordx2 s[24:25], s[0:1], 80
    s_cmp_ge_u32 s2, 256
    s_cbranch_scc1 L_end
    s_bfe_u32 s72, s2, 131073
    s_lshl_b32 s72, s72, 2
    s_bfe_u32 s73, s2, 131075
    s_add_u32 s64, s72, s73
    s_and_b32 s72, s2, 1
    s_lshl_b32 s72, s72, 3
    s_lshr_b32 s74, s2, 5
    s_add_u32 s65, s72, s74
    s_mov_b32 s66, s65
    s_lshr_b32 s68, s65, 1
    s_and_b32 s69, s65, 1
    s_sub_u32 s72, s74, 5
    s_cselect_b32 s3, s74, s72
    v_lshrrev_b32 v11, 6, v0
    s_nop 0
    v_readfirstlane_b32 s67, v11
    v_and_b32 v16, 63, v0
    v_lshlrev_b32 v1, 4, v16
    v_lshrrev_b32 v2, 4, v16
    v_and_b32 v3, 15, v16
    s_getpc_b64 s[76:77]
L_pc:
        s_sub_u32 s76, s76, L_pc-sequential_preLN__linear_kernel_hedgehog__glu_gated_geglu__prompt_kernel
        s_subb_u32 s77, s77, 0
    s_lshr_b32 s78, s2, 3
    s_lshl_b32 s78, s78, 2
    s_add_u32 s78, s78, s67
    s_mul_i32 s78, s78, 384
    v_min_u32 v11, 2, v16
    v_lshlrev_b32 v11, 7, v11
    v_add_u32 v11, s78, v11
    v_min_u32 v11, L_end-sequential_preLN__linear_kernel_hedgehog__glu_gated_geglu__prompt_kernel, v11
    v_mov_b32 v95, s77
    v_add_co_u32 v94, vcc, s76, v11
    s_nop 1
    v_addc_co_u32 v95, vcc, 0, v95, vcc
    global_load_dword v93, v[94:95], off
    s_mul_i32 s72, s67, 192
    s_movk_i32 s73, 3840
    s_movk_i32 s76, 1200
    v_add_u32 v11, s72, v16
    v_mul_u32_u24 v12, 4370, v11
    v_lshrrev_b32 v12, 16, v12
    v_mul_u32_u24 v13, 15, v12
    v_sub_u32 v11, v11, v13
    v_lshlrev_b32 v13, 4, v11
    v_mad_u32_u24 v18, v12, s73, v13
    v_mul_u32_u24 v11, 52, v11
    v_lshrrev_b32 v11, 8, v11
    v_mad_u32_u24 v18, v11, s76, v18
    v_add_u32 v11, s72, v16
    v_add_u32 v11, 64, v11
    v_mul_u32_u24 v12, 4370, v11
    v_lshrrev_b32 v12, 16, v12
    v_mul_u32_u24 v13, 15, v12
    v_sub_u32 v11, v11, v13
    v_lshlrev_b32 v13, 4, v11
    v_mad_u32_u24 v19, v12, s73, v13
    v_mul_u32_u24 v11, 52, v11
    v_lshrrev_b32 v11, 8, v11
    v_mad_u32_u24 v19, v11, s76, v19
    v_subrev_u32 v19, 1024, v19
    v_add_u32 v11, s72, v16
    v_add_u32 v11, 128, v11
    v_mul_u32_u24 v12, 4370, v11
    v_lshrrev_b32 v12, 16, v12
    v_mul_u32_u24 v13, 15, v12
    v_sub_u32 v11, v11, v13
    v_lshlrev_b32 v13, 4, v11
    v_mad_u32_u24 v20, v12, s73, v13
    v_mul_u32_u24 v11, 52, v11
    v_lshrrev_b32 v11, 8, v11
    v_mad_u32_u24 v20, v11, s76, v20
    v_subrev_u32 v20, 2048, v20
    v_xor_b32 v11, v3, v2
    v_lshlrev_b32 v11, 4, v11
    v_mul_u32_u24 v12, 1280, v2
    v_xor_b32 v30, 0, v11
    v_add_u32 v30, v30, v12
    v_xor_b32 v31, 64, v11
    v_add_u32 v31, v31, v12
    v_add_u32 v31, 4096, v31
    v_xor_b32 v32, 128, v11
    v_add_u32 v32, v32, v12
    v_add_u32 v32, 8192, v32
    v_xor_b32 v33, 192, v11
    v_add_u32 v33, v33, v12
    v_add_u32 v33, 12288, v33
    s_lshl_b32 s72, s64, 7
    s_lshl_b32 s73, s67, 5
    s_add_u32 s72, s72, s73
    s_mul_i32 s80, s72, 1280
    s_lshl_b32 s81, s67, 13
    s_mul_i32 s88, s64, 153600
    s_mul_i32 s72, s65, 80
    s_add_u32 s88, s88, s72
    s_mul_i32 s89, s67, 3072
    s_add_u32 m0, s89, 118784
    s_mul_i32 s74, s65, 1600
    s_waitcnt lgkmcnt(0)
    s_mov_b32 s32, s6
    s_mov_b32 s33, s7
    s_mov_b32 s34, 2457600
    s_mov_b32 s35, 131072
    buffer_load_dwordx4 v18, s[32:35], s88 offen offset:0 nt lds
    buffer_load_dwordx4 v19, s[32:35], s88 offen offset:1024 nt lds
    buffer_load_dwordx4 v20, s[32:35], s88 offen offset:2048 nt lds
    s_mov_b32 s28, s4
    s_mov_b32 s29, s5
    s_mov_b32 s30, 2621440
    s_mov_b32 s31, 131072
    s_load_dwordx2 s[70:71], s[24:25], 0
    s_mov_b32 s60, s8
    s_mov_b32 s61, s9
    s_mov_b32 s62, 25600
    s_mov_b32 s63, 131072
    v_lshlrev_b32 v58, 3, v0
    v_cmp_gt_u32 vcc, 200, v0
    v_mov_b32 v12, 1073741824
    s_nop 0
    v_cndmask_b32 v58, v12, v58, vcc
    buffer_load_dwordx2 v[56:57], v58, s[60:63], s74 offen
    s_mov_b32 s36, s24
    s_mov_b32 s37, s25
    s_mov_b32 s38, 67108864
    s_mov_b32 s39, 131072
    s_mov_b32 s40, s14
    s_mov_b32 s41, s15
    s_mov_b32 s42, 1966080
    s_mov_b32 s43, 131072
    s_mov_b32 s44, s16
    s_mov_b32 s45, s17
    s_mov_b32 s46, 1966080
    s_mov_b32 s47, 131072
    s_mov_b32 s48, s18
    s_mov_b32 s49, s19
    s_mov_b32 s50, 1966080
    s_mov_b32 s51, 131072
    s_mov_b32 s52, s10
    s_mov_b32 s53, s11
    s_mov_b32 s54, 819200
    s_mov_b32 s55, 131072
    s_mov_b32 s56, s20
    s_mov_b32 s57, s21
    s_mov_b32 s58, 2621440
    s_mov_b32 s59, 131072
    v_mov_b32 v64, 0
    v_mov_b32 v65, 0
    v_mov_b32 v66, 0
    v_mov_b32 v67, 0
    v_lshlrev_b32 v11, 4, v0
    v_add_u32 v11, 143360, v11
    ds_write_b128 v11, v[64:67] offset:0
    ds_write_b128 v11, v[64:67] offset:4096
    v_cmp_gt_u32 vcc, 128, v0
    s_nop 0
    s_and_saveexec_b64 s[72:73], vcc
    ds_write_b128 v11, v[64:67] offset:8192
    s_mov_b64 exec, s[72:73]
    v_bfe_u32 v14, v16, 2, 2
    v_and_b32 v15, 3, v16
    s_mov_b32 s92, 16256
    s_mov_b32 s93, 1065353216
    s_mov_b32 s94, 1065369472
    s_lshl_b32 s72, s67, 3
    s_lshr_b32 s17, 550008912, s72
    s_and_b32 s17, s17, 255
    s_lshr_b32 s18, 671129712, s72
    s_and_b32 s18, s18, 255
    s_lshr_b32 s19, 671614984, s72
    s_and_b32 s19, s19, 255
    s_lshr_b32 s20, 134744104, s72
    s_and_b32 s20, s20, 255
    s_lshr_b32 s21, 16974595, s72
    s_and_b32 s21, s21, 255
    s_mul_i32 s73, s65, 102400
    s_add_u32 s73, s73, 25165824
    s_mul_i32 s74, s65, 61440
    s_add_u32 s74, s74, 27257856
    s_lshl_b32 s75, s67, 11
    s_movk_i32 s76, 3072
    s_cmp_lt_u32 s67, 3
    s_cselect_b32 s22, s73, s74
    s_cselect_b32 s24, 5120, s76
    s_cmp_lt_u32 s67, 2
    s_cselect_b32 s23, s73, s74
    s_cselect_b32 s25, 5120, s76
    s_add_u32 s22, s22, s75
    s_add_u32 s23, s23, s75
    s_add_u32 s23, s23, 1024
    v_and_b32 v68, s21, v15
    v_mul_u32_u24 v68, s19, v68
    v_add_u32 v68, s17, v68
    v_mul_u32_u24 v69, s20, v15
    v_add_u32 v69, s18, v69
    v_lshl_add_u32 v11, v2, 3, v14
    v_mul_u32_u24 v11, 240, v11
    v_add_u32 v11, 118784, v11
    v_add_u32 v21, v11, v68
    v_add_u32 v22, v11, v69
    v_and_b32 v12, 1, v2
    v_cmp_eq_u32 vcc, 1, v12
    v_mul_u32_u24 v11, 240, v14
    v_add_u32 v11, 126464, v11
    v_cndmask_b32 v68, v68, v69, vcc
    v_add_u32 v23, v11, v68
    s_mul_i32 s72, s64, 5
    v_add_u32 v11, s72, v2
    v_lshrrev_b32 v13, 2, v11
    v_and_b32 v11, 3, v11
    v_lshlrev_b32 v11, 8, v11
    v_lshl_add_u32 v11, v3, 4, v11
    v_mad_u32_u24 v40, v13, s24, v11
    v_mad_u32_u24 v41, v13, s25, v11
    s_add_u32 s72, s72, 4
    s_lshr_b32 s73, s72, 2
    s_and_b32 s72, s72, 3
    s_lshl_b32 s72, s72, 8
    s_mul_i32 s74, s73, s24
    s_add_u32 s74, s74, s22
    s_add_u32 s74, s74, s72
    s_mul_i32 s75, s73, s25
    s_add_u32 s75, s75, s23
    s_add_u32 s75, s75, s72
    v_mov_b32 v11, s74
    v_mov_b32 v13, s75
    v_cndmask_b32 v11, v11, v13, vcc
    v_lshl_add_u32 v11, v3, 4, v11
    v_mov_b32 v13, 1073741824
    v_cmp_gt_u32 vcc, 2, v2
    s_nop 1
    v_cndmask_b32 v42, v13, v11, vcc
    v_lshrrev_b32 v11, 1, v2
    v_lshlrev_b32 v11, 10, v11
    v_lshl_add_u32 v11, v3, 4, v11
    v_cmp_eq_u32 vcc, 0, v12
    s_nop 1
    v_cndmask_b32 v43, v13, v11, vcc
    s_lshl_b32 s91, s65, 13
    s_lshl_b32 s72, s67, 11
    s_add_u32 s91, s91, s72
    s_lshr_b32 s72, s64, 2
    s_lshl_b32 s72, s72, 8
    s_add_u32 s91, s91, s72
    s_and_b32 s72, s64, 3
    s_lshl_b32 s72, s72, 2
    s_add_u32 s91, s91, s72
    s_add_u32 s91, s91, 28311552
    v_mul_u32_u24 v11, 205, v0
    v_lshrrev_b32 v11, 10, v11
    v_mul_u32_u24 v12, 5, v11
    v_sub_u32 v12, v0, v12
    v_lshlrev_b32 v58, 11, v12
    v_cmp_lt_u32 vcc, 19, v11
    s_nop 1
    v_cndmask_b32 v12, 0, 1, vcc
    v_mul_u32_u24 v13, 20, v12
    v_sub_u32 v11, v11, v13
    v_lshl_add_u32 v58, v12, 6, v58
    v_lshrrev_b32 v68, 2, v11
    v_lshlrev_b32 v68, 8, v68
    v_and_b32 v69, 3, v11
    v_lshl_add_u32 v68, v69, 1, v68
    v_mul_u32_u24 v13, 1032, v12
    v_add_u32 v68, v68, v13
    v_lshlrev_b32 v69, 1, v69
    v_lshl_add_u32 v69, v12, 8, v69
    v_add_u32 v69, 8, v69
    v_cmp_lt_u32 vcc, 15, v11
    s_nop 1
    v_cndmask_b32 v68, v68, v69, vcc
    v_add_u32 v58, v58, v68
    v_add_u32 v58, 143360, v58
    v_cmp_ne_u32 vcc, 0, v0
    v_mov_b32 v12, 1073741824
    s_nop 0
    v_cndmask_b32 v5, 0, v12, vcc
    s_lshl_b32 s72, s67, 7
    v_add_u32 v11, s72, v16
    v_mul_u32_u24 v12, 171, v11
    v_lshrrev_b32 v12, 11, v12
    v_mul_u32_u24 v13, 12, v12
    v_sub_u32 v13, v11, v13
    v_mul_u32_u24 v26, 3072, v12
    v_lshl_add_u32 v26, v13, 4, v26
    v_mul_u32_u24 v12, 205, v11
    v_lshrrev_b32 v12, 11, v12
    v_mul_u32_u24 v13, 10, v12
    v_sub_u32 v13, v11, v13
    v_mul_u32_u24 v28, 1280, v12
    v_lshl_add_u32 v28, v13, 4, v28
    s_lshl_b32 s72, s67, 7
    v_add_u32 v11, s72, v16
    v_add_u32 v11, 64, v11
    v_mul_u32_u24 v12, 171, v11
    v_lshrrev_b32 v12, 11, v12
    v_mul_u32_u24 v13, 12, v12
    v_sub_u32 v13, v11, v13
    v_mul_u32_u24 v27, 3072, v12
    v_lshl_add_u32 v27, v13, 4, v27
    v_mul_u32_u24 v12, 205, v11
    v_lshrrev_b32 v12, 11, v12
    v_mul_u32_u24 v13, 10, v12
    v_sub_u32 v13, v11, v13
    v_mul_u32_u24 v29, 1280, v12
    v_lshl_add_u32 v29, v13, 4, v29
    s_add_u32 s99, s3, 0
    s_sub_u32 s100, s99, 5
    s_cselect_b32 s99, s99, s100
    s_lshl_b32 s99, s99, 8
    s_add_u32 s99, s99, s80
    s_add_u32 m0, s81, 0
    s_nop 0
    buffer_load_dwordx4 v30, s[28:31], s99 offen offset:0 lds
    buffer_load_dwordx4 v31, s[28:31], s99 offen offset:1024 lds
    buffer_load_dwordx4 v32, s[28:31], s99 offen offset:2048 lds
    buffer_load_dwordx4 v33, s[28:31], s99 offen offset:3072 lds
    s_add_u32 s99, s99, 20480
    s_add_u32 m0, s81, 4096
    s_nop 0
    buffer_load_dwordx4 v30, s[28:31], s99 offen offset:0 lds
    buffer_load_dwordx4 v31, s[28:31], s99 offen offset:1024 lds
    buffer_load_dwordx4 v32, s[28:31], s99 offen offset:2048 lds
    buffer_load_dwordx4 v33, s[28:31], s99 offen offset:3072 lds
    s_waitcnt vmcnt(9)
    s_waitcnt lgkmcnt(0)
    s_add_u32 s70, s70, 1
    s_addc_u32 s71, s71, 0
    v_mov_b32 v8, s70
    v_mov_b32 v9, s71
    s_mul_i32 s86, s70, 2654435761
    s_add_u32 s86, s86, s71
    s_barrier
    ds_read_b64_tr_b16 v[72:73], v21 offset:0
    ds_read_b64_tr_b16 v[74:75], v21 offset:960
    ds_read_b64_tr_b16 v[76:77], v22 offset:0
    ds_read_b64_tr_b16 v[78:79], v22 offset:960
    ds_read_b64_tr_b16 v[80:81], v23 offset:0
    ds_read_b64_tr_b16 v[82:83], v23 offset:960
    s_waitcnt lgkmcnt(4)
    buffer_store_dwordx4 v[72:75], v40, s[36:39], s22 offen sc1
    s_waitcnt lgkmcnt(2)
    buffer_store_dwordx4 v[76:79], v41, s[36:39], s23 offen sc1
    s_waitcnt lgkmcnt(0)
    buffer_store_dwordx4 v[80:83], v42, s[36:39], 0 offen sc1
    v_mov_b32 v84, 0
    v_mov_b32 v85, 0
    v_mov_b32 v86, 0
    v_dot2_f32_bf16 v84, v72, s94, v84
    v_dot2_f32_bf16 v85, v76, s94, v85
    v_dot2_f32_bf16 v86, v80, s94, v86
    v_dot2_f32_bf16 v84, v73, s94, v84
    v_dot2_f32_bf16 v85, v77, s94, v85
    v_dot2_f32_bf16 v86, v81, s94, v86
    v_dot2_f32_bf16 v84, v74, s94, v84
    v_dot2_f32_bf16 v85, v78, s94, v85
    v_dot2_f32_bf16 v86, v82, s94, v86
    v_dot2_f32_bf16 v84, v75, s94, v84
    v_dot2_f32_bf16 v85, v79, s94, v85
    v_dot2_f32_bf16 v86, v83, s94, v86
    v_cmp_eq_u32 vcc, 0, v2
    v_cmp_eq_u32 s[72:73], 1, v2
    s_nop 0
    v_cndmask_b32 v11, 0, v86, vcc
    v_cndmask_b32 v12, 0, v86, s[72:73]
    v_add_f32 v84, v84, v11
    v_add_f32 v85, v85, v12
    s_nop 1
    v_permlane32_swap_b32 v84, v85
    v_add_f32 v84, v84, v85
    v_mov_b32 v85, v84
    s_nop 1
    v_permlane16_swap_b32 v84, v85
    v_add_f32 v84, v84, v85
    v_cvt_pk_bf16_f32 v85, v84, v84
    v_lshlrev_b32 v85, 16, v85
    v_sub_f32 v85, v84, v85
    v_cvt_pk_bf16_f32 v85, v84, v85
    buffer_store_dword v85, v43, s[36:39], s91 offen sc1
    v_cmp_gt_u32 vcc, 200, v0
    s_nop 0
    s_and_saveexec_b64 s[72:73], vcc
    s_waitcnt vmcnt(12)
    ds_write_b16 v58, v56
    ds_write_b16_d16_hi v58, v56 offset:16
    ds_write_b16 v58, v57 offset:32
    ds_write_b16_d16_hi v58, v57 offset:48
    s_mov_b64 exec, s[72:73]
    v_mov_b32 v60, 1065369472
    s_add_u32 s99, s3, 1
    s_sub_u32 s100, s99, 5
    s_cselect_b32 s99, s99, s100
    s_lshl_b32 s99, s99, 8
    s_add_u32 s99, s99, s80
    s_add_u32 m0, s81, 32768
    s_nop 0
    buffer_load_dwordx4 v30, s[28:31], s99 offen offset:0 lds
    v_mov_b32 v61, 1065369472
    v_mov_b32 v62, 1065369472
    buffer_load_dwordx4 v31, s[28:31], s99 offen offset:1024 lds
    v_mov_b32 v63, 1065369472
    v_lshlrev_b32 v6, 7, v3
    v_lshlrev_b32 v7, 11, v3
    buffer_load_dwordx4 v32, s[28:31], s99 offen offset:2048 lds
    v_mul_u32_u24 v10, 1280, v3
    v_mul_u32_u24 v11, 40, v2
    v_add_u32 v10, v10, v11
    buffer_load_dwordx4 v33, s[28:31], s99 offen offset:3072 lds
    s_add_u32 s72, s81, 0
    v_xor_b32 v11, v3, v2
    v_lshlrev_b32 v11, 4, v11
    v_lshl_add_u32 v13, v3, 8, v11
    s_add_u32 s99, s99, 20480
    s_add_u32 m0, s81, 36864
    s_nop 0
    buffer_load_dwordx4 v30, s[28:31], s99 offen offset:0 lds
    v_xor_b32 v34, 0, v13
    v_add_u32 v34, s72, v34
    v_xor_b32 v35, 64, v13
    buffer_load_dwordx4 v31, s[28:31], s99 offen offset:1024 lds
    v_add_u32 v35, s72, v35
    v_xor_b32 v36, 128, v13
    v_add_u32 v36, s72, v36
    buffer_load_dwordx4 v32, s[28:31], s99 offen offset:2048 lds
    v_xor_b32 v37, 192, v13
    v_add_u32 v37, s72, v37
    v_add_u32 v17, 4096, v1
    buffer_load_dwordx4 v33, s[28:31], s99 offen offset:3072 lds
    v_add_u32 v38, 61440, v1
    v_add_u32 v39, 102400, v1
    s_mov_b32 s4, 0x3fb8aa3b
    s_mov_b32 s5, 0x3acccccd
    s_mov_b32 s6, 0x3727c5ac
    s_mov_b32 s7, 0xc0135761
    s_mov_b32 s8, 0xbdd2d3e8
    s_mov_b32 s9, 0x358637bd
    s_mov_b32 s10, 0x3fb8aa3b
    s_mov_b32 s11, 0xbfb8aa3b
    s_waitcnt vmcnt(8)
    s_waitcnt lgkmcnt(0)
    s_barrier
    s_lshl_b32 s72, s64, 11
    s_lshl_b32 s73, s65, 7
    s_add_u32 s72, s72, s73
    s_add_u32 s72, s72, 233472
    buffer_store_dwordx2 v[8:9], v5, s[36:39], s72 offen sc1
    v_lshrrev_b32 v44, 1, v2
    s_add_u32 s99, s3, 2
    s_sub_u32 s100, s99, 5
    s_cselect_b32 s99, s99, s100
    s_lshl_b32 s99, s99, 8
    s_add_u32 s99, s99, s80
    s_add_u32 m0, s81, 65536
    s_nop 0
    buffer_load_dwordx4 v30, s[28:31], s99 offen offset:0 lds
    v_mul_u32_u24 v44, 20480, v44
    v_lshl_add_u32 v44, v3, 4, v44
    v_and_b32 v46, 1, v2
    v_lshl_add_u32 v45, v46, 3, v44
    s_mul_i32 s87, s64, 163840
    s_mul_i32 s78, s67, 40960
    s_add_u32 s87, s87, s78
    s_mul_i32 s78, s66, 1280
    s_add_u32 s87, s87, s78
    s_add_u32 s87, s87, 2097152
    v_lshl_add_u32 v44, v46, 9, v44
    v_and_b32 v11, 1, v15
    v_lshlrev_b32 v11, 13, v11
    v_lshrrev_b32 v12, 1, v15
    buffer_load_dwordx4 v31, s[28:31], s99 offen offset:1024 lds
    v_lshl_add_u32 v11, v12, 3, v11
    s_mul_i32 s72, s67, 48
    s_add_u32 s72, s72, 40960
    v_add_u32 v11, s72, v11
    v_lshrrev_b32 v12, 1, v2
    v_mul_u32_u24 v12, 20, v12
    v_and_b32 v13, 1, v2
    v_lshl_add_u32 v12, v13, 3, v12
    v_add_u32 v12, v12, v14
    v_mul_u32_u24 v12, 192, v12
    buffer_load_dwordx4 v32, s[28:31], s99 offen offset:2048 lds
    v_add_u32 v220, v11, v12
    v_mul_u32_u24 v12, 192, v14
    v_min_u32 v13, 2, v2
    v_lshl_add_u32 v12, v13, 4, v12
    v_add_u32 v221, v11, v12
    v_lshrrev_b32 v11, 1, v14
    v_lshlrev_b32 v11, 3, v11
    v_lshrrev_b32 v12, 1, v15
    buffer_load_dwordx4 v33, s[28:31], s99 offen offset:3072 lds
    v_lshl_add_u32 v11, v12, 2, v11
    v_and_b32 v12, 1, v14
    v_lshl_add_u32 v11, v12, 1, v11
    v_and_b32 v12, 1, v15
    v_add_u32 v11, v11, v12
    v_lshlrev_b32 v11, 4, v11
    v_lshl_add_u32 v222, v2, 8, v11
    v_mul_u32_u24 v12, 20480, v2
    s_add_u32 s99, s99, 20480
    s_add_u32 m0, s81, 69632
    s_nop 0
    buffer_load_dwordx4 v30, s[28:31], s99 offen offset:0 lds
    v_add_u32 v12, v12, v11
    v_mov_b32 v13, 1073741824
    v_cmp_gt_u32 vcc, 3, v2
    s_nop 1
    v_cndmask_b32 v223, v13, v12, vcc
    s_lshl_b32 s72, s67, 2
    s_lshl_b32 s73, s69, 4
    s_add_u32 s72, s72, s73
    v_add_u32 v11, s72, v2
    v_cmp_gt_u32 vcc, 25, v11
    v_min_u32 v11, 24, v11
    v_mul_u32_u24 v12, 205, v11
    v_lshrrev_b32 v12, 10, v12
    buffer_load_dwordx4 v31, s[28:31], s99 offen offset:1024 lds
    v_mul_u32_u24 v13, 5, v12
    v_sub_u32 v13, v11, v13
    v_mul_u32_u24 v232, 40, v15
    v_lshl_add_u32 v232, v13, 3, v232
    v_lshrrev_b32 v230, 1, v12
    v_mul_u32_u24 v230, 20, v230
    v_and_b32 v231, 1, v12
    v_lshl_add_u32 v230, v231, 3, v230
    buffer_load_dwordx4 v32, s[28:31], s99 offen offset:2048 lds
    v_cmp_eq_u32 s[74:75], 4, v12
    s_nop 1
    v_cndmask_b32 v230, v230, 16, s[74:75]
    v_cndmask_b32 v231, 4, 20, s[74:75]
    v_add_u32 v230, v230, v14
    v_add_u32 v231, v231, v230
    v_add_u32 v232, 135168, v232
    s_movk_i32 s76, 160
    v_mad_u32_u24 v230, v230, s76, v232
    v_mad_u32_u24 v231, v231, s76, v232
    buffer_load_dwordx4 v33, s[28:31], s99 offen offset:3072 lds
    s_mul_i32 s72, s64, 5
    v_add_u32 v12, s72, v12
    v_lshrrev_b32 v232, 2, v12
    v_mul_u32_u24 v232, 5120, v232
    v_and_b32 v12, 3, v12
    v_lshl_add_u32 v232, v12, 8, v232
    v_lshl_add_u32 v232, v13, 10, v232
    v_lshl_add_u32 v232, v3, 4, v232
    v_mov_b32 v11, 1073741824
    s_lshl_b32 s26, s64, 7
    s_lshl_b32 s27, s65, 3
    s_add_u32 s26, s26, s27
    s_lshl_b32 s27, s67, 1
    s_add_u32 s82, s26, s27
    s_mul_i32 s26, s82, 1280
    v_mov_b32 v124, 1073741824
    v_cmp_gt_u32 s[24:25], 32, v16
    s_nop 1
    v_cndmask_b32 v124, v124, v1, s[24:25]
    buffer_load_dwordx4 v[104:107], v1, s[28:31], s26 offen offset:0
    v_cndmask_b32 v232, v11, v232, vcc
    s_lshl_b32 s72, s67, 3
    s_add_u32 s72, s72, 0
    v_add_u32 v11, s72, v2
    v_cmp_gt_u32 vcc, 30, v11
    v_min_u32 v11, 29, v11
    v_mul_u32_u24 v12, 205, v11
    v_lshrrev_b32 v12, 10, v12
    v_mul_u32_u24 v13, 5, v12
    v_sub_u32 v13, v11, v13
    v_mul_u32_u24 v226, 40, v15
    buffer_load_dwordx4 v[108:111], v1, s[28:31], s26 offen offset:1024
    v_lshl_add_u32 v226, v13, 3, v226
    v_mul_u32_u24 v224, 171, v12
    v_lshrrev_b32 v224, 9, v224
    v_mul_u32_u24 v225, 3, v224
    v_sub_u32 v225, v12, v225
    v_mul_u32_u24 v224, 24, v224
    v_and_b32 v233, 1, v14
    v_add_u32 v224, v224, v233
    buffer_load_dwordx4 v[112:115], v124, s[28:31], s26 offen offset:2048
    v_lshrrev_b32 v233, 1, v14
    v_lshlrev_b32 v233, 2, v233
    v_cmp_eq_u32 s[74:75], 2, v225
    v_lshlrev_b32 v225, 1, v225
    s_nop 0
    v_cndmask_b32 v225, v225, -8, s[74:75]
    v_add3_u32 v224, v224, v225, 12
    v_cndmask_b32 v225, 4, -2, s[74:75]
    v_add3_u32 v225, v225, v224, v233
    s_lshl_b32 s90, s67, 11
    s_mul_i32 s99, s64, 51200
    s_mul_i32 s100, s68, 160
    s_add_u32 s99, s99, s100
    s_add_u32 m0, s90, 135168
    s_nop 0
    buffer_load_dwordx4 v28, s[52:55], s99 offen nt lds
    v_sub_u32 v224, v224, v233
    v_add_u32 v226, 57344, v226
    s_movk_i32 s76, 160
    v_mad_u32_u24 v224, v224, s76, v226
    v_mad_u32_u24 v225, v225, s76, v226
    s_lshl_b32 s72, s64, 1
    s_add_u32 s72, s72, s69
    s_mul_i32 s72, s72, 6
    v_add_u32 v12, s72, v12
    v_lshrrev_b32 v226, 2, v12
    v_mul_u32_u24 v226, 5120, v226
    v_and_b32 v12, 3, v12
    s_add_u32 m0, s90, 136192
    s_nop 0
    buffer_load_dwordx4 v29, s[52:55], s99 offen nt lds
    v_lshl_add_u32 v226, v12, 8, v226
    v_lshl_add_u32 v226, v13, 10, v226
    v_lshl_add_u32 v226, v3, 4, v226
    v_mov_b32 v11, 1073741824
    v_cndmask_b32 v226, v11, v226, vcc
    s_lshl_b32 s72, s67, 3
    s_add_u32 s72, s72, 4
    v_add_u32 v11, s72, v2
    v_cmp_gt_u32 vcc, 30, v11
    v_min_u32 v11, 29, v11
    v_mul_u32_u24 v12, 205, v11
    s_add_u32 s99, s3, 3
    s_sub_u32 s100, s99, 5
    s_cselect_b32 s99, s99, s100
    s_lshl_b32 s99, s99, 8
    s_add_u32 s99, s99, s80
    s_add_u32 m0, s81, 102400
    s_nop 0
    buffer_load_dwordx4 v30, s[28:31], s99 offen offset:0 lds
    v_lshrrev_b32 v12, 10, v12
    v_mul_u32_u24 v13, 5, v12
    v_sub_u32 v13, v11, v13
    v_mul_u32_u24 v229, 40, v15
    v_lshl_add_u32 v229, v13, 3, v229
    v_mul_u32_u24 v227, 171, v12
    v_lshrrev_b32 v227, 9, v227
    v_mul_u32_u24 v228, 3, v227
    buffer_load_dwordx4 v31, s[28:31], s99 offen offset:1024 lds
    v_sub_u32 v228, v12, v228
    v_mul_u32_u24 v227, 24, v227
    v_and_b32 v233, 1, v14
    v_add_u32 v227, v227, v233
    v_lshrrev_b32 v233, 1, v14
    v_lshlrev_b32 v233, 2, v233
    v_cmp_eq_u32 s[74:75], 2, v228
    v_lshlrev_b32 v228, 1, v228
    buffer_load_dwordx4 v32, s[28:31], s99 offen offset:2048 lds
    v_cndmask_b32 v228, v228, -8, s[74:75]
    v_add3_u32 v227, v227, v228, 12
    v_cndmask_b32 v228, 4, -2, s[74:75]
    v_add3_u32 v228, v228, v227, v233
    v_sub_u32 v227, v227, v233
    v_add_u32 v229, 57344, v229
    s_movk_i32 s76, 160
    v_mad_u32_u24 v227, v227, s76, v229
    v_mad_u32_u24 v228, v228, s76, v229
    buffer_load_dwordx4 v33, s[28:31], s99 offen offset:3072 lds
    s_lshl_b32 s72, s64, 1
    s_add_u32 s72, s72, s69
    s_mul_i32 s72, s72, 6
    v_add_u32 v12, s72, v12
    v_lshrrev_b32 v229, 2, v12
    v_mul_u32_u24 v229, 5120, v229
    v_and_b32 v12, 3, v12
    v_lshl_add_u32 v229, v12, 8, v229
    v_lshl_add_u32 v229, v13, 10, v229
    v_lshl_add_u32 v229, v3, 4, v229
    v_mov_b32 v11, 1073741824
    v_cndmask_b32 v229, v11, v229, vcc
    s_add_u32 s99, s99, 20480
    s_add_u32 m0, s81, 106496
    s_nop 0
    buffer_load_dwordx4 v30, s[28:31], s99 offen offset:0 lds
    s_mul_i32 s74, s67, 9216
    s_add_u32 s74, s74, 65536
    v_mul_u32_u24 v11, 288, v3
    v_add_u32 v11, s74, v11
    v_lshl_add_u32 v248, v2, 3, v11
    v_and_b32 v12, 1, v2
    v_mul_u32_u24 v12, 48, v12
    v_lshrrev_b32 v13, 1, v2
    v_lshlrev_b32 v13, 3, v13
    v_sub_u32 v12, v12, v13
    buffer_load_dwordx4 v31, s[28:31], s99 offen offset:1024 lds
    v_add_u32 v249, v11, v12
    v_lshrrev_b32 v12, 1, v2
    v_mul_u32_u24 v12, 4608, v12
    v_and_b32 v13, 1, v2
    v_mul_u32_u24 v13, 80, v13
    v_add3_u32 v250, v11, v12, v13
    s_lshr_b32 s74, s67, 1
    s_and_b32 s75, s67, 1
    v_lshl_add_u32 v11, v2, 2, v14
    v_mul_u32_u24 v11, 288, v11
    buffer_load_dwordx4 v32, s[28:31], s99 offen offset:2048 lds
    s_mul_i32 s76, s74, 80
    s_add_u32 s76, s76, 65536
    v_lshl_add_u32 v251, v15, 3, v11
    v_add_u32 v251, s76, v251
    s_mul_i32 s76, s74, 48
    s_lshl_b32 s77, s75, 5
    s_add_u32 s76, s76, s77
    s_add_u32 s76, s76, 65696
    s_mul_i32 s77, s75, -2
    s_add_u32 s77, s77, 3
    v_min_u32 v12, s77, v15
    v_lshl_add_u32 v252, v12, 3, v11
    v_add_u32 v252, s76, v252
    s_mul_i32 s76, s75, -176
    s_add_u32 s76, s76, 256
    s_mul_i32 s77, s75, -11
    s_add_u32 s77, s77, 16
    s_mul_i32 s78, s75, 1280
    s_mul_i32 s79, s74, 1792
    s_add_u32 s78, s78, s79
    v_mul_u32_u24 v11, s76, v2
    v_lshlrev_b32 v12, 4, v3
    v_add3_u32 v254, v11, v12, s78
    buffer_load_dwordx4 v33, s[28:31], s99 offen offset:3072 lds
    s_lshl_b32 s76, s76, 2
    s_add_u32 s78, s78, s76
    v_lshl_add_u32 v11, v2, 3, v12
    v_add_u32 v255, s78, v11
    v_mov_b32 v13, 1073741824
    v_cmp_gt_u32 vcc, s77, v3
    s_nop 1
    v_cndmask_b32 v254, v13, v254, vcc
    v_cndmask_b32 v255, v13, v255, vcc
    v_cmp_gt_u32 vcc, 2, v2
    s_nop 1
    v_cndmask_b32 v255, v13, v255, vcc
    s_mul_i32 s89, s67, 5120
    s_mul_i32 s88, s67, 3072
    s_mul_i32 s17, s65, 102400
    s_add_u32 s17, s17, s89
    s_add_u32 s17, s17, 25165824
    s_mul_i32 s19, s65, 61440
    s_add_u32 s19, s19, s88
    s_add_u32 s19, s19, 27262976
    s_lshl_b32 s91, s65, 13
    s_lshl_b32 s90, s67, 11
    s_add_u32 s91, s91, s90
    s_add_u32 s91, s91, 28311552
    s_lshl_b32 s25, s65, 7
    s_add_u32 s25, s25, 233472
    buffer_load_dwordx2 v[18:19], v7, s[36:39], s25 offen sc1
    ds_read_b128 a[0:3], v34 offset:0
    ds_read_b128 a[4:7], v35 offset:0
    ds_read_b128 a[8:11], v36 offset:0
    ds_read_b128 a[12:15], v37 offset:0
    ds_read_b128 a[16:19], v34 offset:4096
    ds_read_b128 a[20:23], v35 offset:4096
    ds_read_b128 a[24:27], v36 offset:4096
    ds_read_b128 a[28:31], v37 offset:4096
    s_waitcnt vmcnt(23)
    ds_read_b128 a[32:35], v34 offset:32768
    ds_read_b128 a[36:39], v35 offset:32768
    ds_read_b128 a[40:43], v36 offset:32768
    ds_read_b128 a[44:47], v37 offset:32768
    ds_read_b128 a[48:51], v34 offset:36864
    ds_read_b128 a[52:55], v35 offset:36864
    ds_read_b128 a[56:59], v36 offset:36864
    ds_read_b128 a[60:63], v37 offset:36864
    s_waitcnt vmcnt(14)
    v_add_u32 v184, 65536, v34
    ds_read_b128 a[64:67], v184 offset:0
    v_add_u32 v185, 65536, v35
    ds_read_b128 a[68:71], v185 offset:0
    v_add_u32 v186, 65536, v36
    ds_read_b128 a[72:75], v186 offset:0
    v_add_u32 v187, 65536, v37
    ds_read_b128 a[76:79], v187 offset:0
    v_add_u32 v184, 65536, v34
    ds_read_b128 a[80:83], v184 offset:4096
    v_add_u32 v185, 65536, v35
    ds_read_b128 a[84:87], v185 offset:4096
    v_add_u32 v186, 65536, v36
    ds_read_b128 a[88:91], v186 offset:4096
    v_add_u32 v187, 65536, v37
    ds_read_b128 a[92:95], v187 offset:4096
    s_waitcnt lgkmcnt(0)
    s_barrier
    s_waitcnt vmcnt(0)
    v_cmp_ne_u64 vcc, s[70:71], v[18:19]
    s_cbranch_vccz L_pd0
    s_mov_b32 s95, 100000
L_pl0:
    buffer_load_dwordx2 v[18:19], v7, s[36:39], s25 offen sc1
    s_waitcnt vmcnt(0)
    v_cmp_ne_u64 vcc, s[70:71], v[18:19]
    s_cbranch_vccz L_pd0
    s_sub_u32 s95, s95, 1
    s_cbranch_scc0 L_pl0
L_pd0:
    s_add_u32 s18, s3, 0
    s_sub_u32 s79, s18, 5
    s_cselect_b32 s18, s18, s79
    s_mul_i32 s18, s18, 20480
    s_add_u32 s18, s18, s17
    s_add_u32 s32, s36, s18
    s_addc_u32 s33, s37, 0
    s_add_u32 m0, s89, 40960
    s_nop 0
    global_load_lds_dwordx4 v1, s[32:33] offset:0 sc1
    global_load_lds_dwordx4 v1, s[32:33] offset:1024 sc1
    global_load_lds_dwordx4 v1, s[32:33] offset:2048 sc1
    global_load_lds_dwordx4 v1, s[32:33] offset:3072 sc1
    s_add_u32 m0, s89, 45056
    s_nop 0
    global_load_lds_dwordx4 v17, s[32:33] offset:0 sc1
    s_add_u32 s18, s3, 1
    s_sub_u32 s79, s18, 5
    s_cselect_b32 s18, s18, s79
    s_mul_i32 s18, s18, 20480
    s_add_u32 s18, s18, s17
    s_add_u32 s32, s36, s18
    s_addc_u32 s33, s37, 0
    s_add_u32 m0, s89, 61440
    s_nop 0
    global_load_lds_dwordx4 v1, s[32:33] offset:0 sc1
    global_load_lds_dwordx4 v1, s[32:33] offset:1024 sc1
    global_load_lds_dwordx4 v1, s[32:33] offset:2048 sc1
    global_load_lds_dwordx4 v1, s[32:33] offset:3072 sc1
    s_add_u32 m0, s89, 65536
    s_nop 0
    global_load_lds_dwordx4 v17, s[32:33] offset:0 sc1
    v_mov_b32 v116, 0
    v_mov_b32 v117, 0
    v_mov_b32 v118, 0
    v_mov_b32 v119, 0
    v_mov_b32 v120, 0
    v_mov_b32 v121, 0
    v_dot2_f32_bf16 v116, v104, s94, v116
    v_dot2_f32_bf16 v117, v104, v104, v117
    v_dot2_f32_bf16 v118, v108, s94, v118
    v_dot2_f32_bf16 v119, v108, v108, v119
    v_dot2_f32_bf16 v120, v112, s94, v120
    v_dot2_f32_bf16 v121, v112, v112, v121
    v_dot2_f32_bf16 v116, v105, s94, v116
    v_dot2_f32_bf16 v117, v105, v105, v117
    v_dot2_f32_bf16 v118, v109, s94, v118
    v_dot2_f32_bf16 v119, v109, v109, v119
    v_dot2_f32_bf16 v120, v113, s94, v120
    v_dot2_f32_bf16 v121, v113, v113, v121
    v_dot2_f32_bf16 v116, v106, s94, v116
    v_dot2_f32_bf16 v117, v106, v106, v117
    v_dot2_f32_bf16 v118, v110, s94, v118
    v_dot2_f32_bf16 v119, v110, v110, v119
    v_dot2_f32_bf16 v120, v114, s94, v120
    v_dot2_f32_bf16 v121, v114, v114, v121
    v_dot2_f32_bf16 v116, v107, s94, v116
    v_dot2_f32_bf16 v117, v107, v107, v117
    v_dot2_f32_bf16 v118, v111, s94, v118
    v_dot2_f32_bf16 v119, v111, v111, v119
    v_dot2_f32_bf16 v120, v115, s94, v120
    v_dot2_f32_bf16 v121, v115, v115, v121
    v_cmp_eq_u32 vcc, 0, v2
    s_nop 1
    v_cndmask_b32 v122, 0, v118, vcc
    v_cndmask_b32 v118, v118, 0, vcc
    v_cndmask_b32 v123, 0, v119, vcc
    v_cndmask_b32 v119, v119, 0, vcc
    v_add_f32 v116, v116, v122
    v_add_f32 v120, v120, v118
    v_add_f32 v117, v117, v123
    v_add_f32 v121, v121, v119
    v_permlane32_swap_b32 v116, v120
    s_nop 0
    v_permlane32_swap_b32 v117, v121
    v_add_f32 v116, v116, v120
    v_add_f32 v117, v117, v121
    v_mov_b32 v118, v116
    v_mov_b32 v119, v117
    s_nop 0
    v_permlane16_swap_b32 v116, v118
    v_permlane16_swap_b32 v117, v119
    v_add_f32 v116, v116, v118
    v_add_f32 v117, v117, v119
    s_nop 0
    v_add_f32_dpp v116, v116, v116 row_ror:8 row_mask:0xf bank_mask:0xf
    v_add_f32_dpp v117, v117, v117 row_ror:8 row_mask:0xf bank_mask:0xf
    s_nop 0
    v_add_f32_dpp v116, v116, v116 row_ror:4 row_mask:0xf bank_mask:0xf
    v_add_f32_dpp v117, v117, v117 row_ror:4 row_mask:0xf bank_mask:0xf
    s_nop 0
    v_add_f32_dpp v116, v116, v116 row_ror:2 row_mask:0xf bank_mask:0xf
    v_add_f32_dpp v117, v117, v117 row_ror:2 row_mask:0xf bank_mask:0xf
    s_nop 0
    v_add_f32_dpp v116, v116, v116 row_ror:1 row_mask:0xf bank_mask:0xf
    v_add_f32_dpp v117, v117, v117 row_ror:1 row_mask:0xf bank_mask:0xf
    v_mul_f32 v116, s5, v116
    v_mul_f32 v117, s5, v117
    v_fma_f32 v117, -v116, v116, v117
    v_max_f32 v117, 0, v117
    v_add_f32 v117, s6, v117
    v_sub_f32 v116, 0, v116
    v_rsq_f32 v118, v117
    v_mov_b32 v117, s70
    v_mov_b32 v119, s86
    v_lshrrev_b32 v124, 1, v16
    v_and_b32 v125, 31, v16
    v_mov_b32 v126, 1073741824
    v_cmp_eq_u32 vcc, 0, v125
    s_lshl_b32 s26, s82, 4
    s_add_u32 s26, s26, 30408704
    v_cndmask_b32 v124, v126, v124, vcc
    buffer_store_dwordx4 v[116:119], v124, s[36:39], s26 offen sc1
    v_add_u32 v11, 143360, v1
    v_xor_b32 v12, 128, v11
    ds_read_b128 a[160:163], v11 offset:0
    ds_read_b128 a[164:167], v11 offset:1024
    ds_read_b128 a[168:171], v11 offset:2048
    ds_read_b128 a[172:175], v11 offset:3072
    ds_read_b128 a[176:179], v11 offset:4096
    ds_read_b128 a[180:183], v11 offset:5120
    ds_read_b128 a[184:187], v11 offset:6144
    ds_read_b128 a[188:191], v11 offset:7168
    ds_read_b128 a[192:195], v11 offset:8192
    ds_read_b128 a[196:199], v11 offset:9216
    ds_read_b128 a[200:203], v12 offset:0
    ds_read_b128 a[204:207], v12 offset:1024
    ds_read_b128 a[208:211], v12 offset:2048
    ds_read_b128 a[212:215], v12 offset:3072
    ds_read_b128 a[216:219], v12 offset:4096
    ds_read_b128 a[220:223], v12 offset:5120
    ds_read_b128 a[224:227], v12 offset:6144
    ds_read_b128 a[228:231], v12 offset:7168
    ds_read_b128 a[232:235], v12 offset:8192
    ds_read_b128 a[236:239], v12 offset:9216
    s_add_u32 s99, s3, 4
    s_sub_u32 s100, s99, 5
    s_cselect_b32 s99, s99, s100
    s_lshl_b32 s99, s99, 8
    s_add_u32 s99, s99, s80
    s_add_u32 m0, s81, 0
    s_nop 0
    buffer_load_dwordx4 v30, s[28:31], s99 offen offset:0 lds
    buffer_load_dwordx4 v31, s[28:31], s99 offen offset:1024 lds
    buffer_load_dwordx4 v32, s[28:31], s99 offen offset:2048 lds
    buffer_load_dwordx4 v33, s[28:31], s99 offen offset:3072 lds
    s_add_u32 s99, s99, 20480
    s_add_u32 m0, s81, 4096
    s_nop 0
    buffer_load_dwordx4 v30, s[28:31], s99 offen offset:0 lds
    buffer_load_dwordx4 v31, s[28:31], s99 offen offset:1024 lds
    buffer_load_dwordx4 v32, s[28:31], s99 offen offset:2048 lds
    buffer_load_dwordx4 v33, s[28:31], s99 offen offset:3072 lds
    s_waitcnt vmcnt(14)
    s_barrier
    ds_read_b128 v[64:67], v1 offset:40960
    ds_read_b128 v[68:71], v1 offset:41984
    ds_read_b128 v[72:75], v1 offset:43008
    ds_read_b128 v[76:79], v1 offset:44032
    ds_read_b128 v[80:83], v1 offset:45056
    s_waitcnt lgkmcnt(4)
    v_mfma_f32_16x16x32_bf16 v[104:107], v[64:67], a[0:3], 0
    ds_read_b128 v[84:87], v1 offset:46080
    v_mfma_f32_16x16x32_bf16 v[108:111], v[64:67], a[16:19], 0
    ds_read_b64_tr_b16 v[208:209], v230
    ds_read_b64_tr_b16 v[210:211], v231
    s_waitcnt lgkmcnt(6)
    v_mfma_f32_16x16x32_bf16 v[116:119], v[68:71], a[0:3], 0
    ds_read_b128 v[88:91], v1 offset:47104
    s_add_u32 s18, s3, 2
    v_mfma_f32_16x16x32_bf16 v[120:123], v[68:71], a[16:19], 0
    s_sub_u32 s79, s18, 5
    s_cselect_b32 s18, s18, s79
    s_mul_i32 s18, s18, 20480
    s_add_u32 s18, s18, s17
    s_add_u32 s32, s36, s18
    s_addc_u32 s33, s37, 0
    s_add_u32 m0, s89, 81920
    s_nop 0
    global_load_lds_dwordx4 v1, s[32:33] offset:0 sc1
    s_waitcnt lgkmcnt(6)
    v_mfma_f32_16x16x32_bf16 v[128:131], v[72:75], a[0:3], 0
    ds_read_b128 v[92:95], v1 offset:48128
    v_mfma_f32_16x16x32_bf16 v[132:135], v[72:75], a[16:19], 0
    s_mul_i32 s100, s68, 102400
    s_add_u32 s100, s100, 16777216
    s_waitcnt lgkmcnt(2)
    buffer_store_dwordx4 v[208:211], v232, s[36:39], s100 offen sc1
    v_mfma_f32_16x16x32_bf16 v[140:143], v[76:79], a[0:3], 0
    ds_read_b128 v[96:99], v1 offset:49152
    v_mfma_f32_16x16x32_bf16 v[144:147], v[76:79], a[16:19], 0
    v_mfma_f32_16x16x32_bf16 v[152:155], v[80:83], a[0:3], 0
    ds_read_b128 v[100:103], v1 offset:50176
    v_add_u32 v184, 65536, v34
    v_mfma_f32_16x16x32_bf16 v[156:159], v[80:83], a[16:19], 0
    ds_read_b128 a[96:99], v184 offset:36864
    global_load_lds_dwordx4 v1, s[32:33] offset:1024 sc1
    v_mfma_f32_16x16x32_bf16 v[104:107], v[84:87], a[4:7], v[104:107]
    ds_read_b128 v[64:67], v1 offset:51200
    v_add_u32 v185, 65536, v35
    v_mfma_f32_16x16x32_bf16 v[108:111], v[84:87], a[20:23], v[108:111]
    ds_read_b128 a[100:103], v185 offset:36864
    s_waitcnt lgkmcnt(5)
    v_mfma_f32_16x16x32_bf16 v[116:119], v[88:91], a[4:7], v[116:119]
    ds_read_b128 v[68:71], v1 offset:52224
    v_add_u32 v186, 65536, v36
    v_mfma_f32_16x16x32_bf16 v[120:123], v[88:91], a[20:23], v[120:123]
    ds_read_b128 a[104:107], v186 offset:36864
    global_load_lds_dwordx4 v1, s[32:33] offset:2048 sc1
    v_mfma_f32_16x16x32_bf16 v[128:131], v[92:95], a[4:7], v[128:131]
    ds_read_b128 v[72:75], v1 offset:53248
    v_add_u32 v187, 65536, v37
    v_mfma_f32_16x16x32_bf16 v[132:135], v[92:95], a[20:23], v[132:135]
    ds_read_b128 a[108:111], v187 offset:36864
    s_waitcnt lgkmcnt(7)
    v_mfma_f32_16x16x32_bf16 v[140:143], v[96:99], a[4:7], v[140:143]
    ds_read_b128 v[76:79], v1 offset:54272
    v_add_u32 v184, 65536, v34
    v_mfma_f32_16x16x32_bf16 v[144:147], v[96:99], a[20:23], v[144:147]
    ds_read_b128 a[112:115], v184 offset:40960
    global_load_lds_dwordx4 v1, s[32:33] offset:3072 sc1
    v_mfma_f32_16x16x32_bf16 v[152:155], v[100:103], a[4:7], v[152:155]
    ds_read_b128 v[80:83], v1 offset:55296
    v_add_u32 v185, 65536, v35
    v_mfma_f32_16x16x32_bf16 v[156:159], v[100:103], a[20:23], v[156:159]
    ds_read_b128 a[116:119], v185 offset:40960
    s_add_u32 m0, s89, 86016
    s_waitcnt lgkmcnt(7)
    v_mfma_f32_16x16x32_bf16 v[104:107], v[64:67], a[8:11], v[104:107]
    ds_read_b128 v[84:87], v1 offset:56320
    v_add_u32 v186, 65536, v36
    v_mfma_f32_16x16x32_bf16 v[108:111], v[64:67], a[24:27], v[108:111]
    ds_read_b128 a[120:123], v186 offset:40960
    v_add_u32 v187, 65536, v37
    v_mfma_f32_16x16x32_bf16 v[116:119], v[68:71], a[8:11], v[116:119]
    ds_read_b128 v[88:91], v1 offset:57344
    ds_read_b128 a[124:127], v187 offset:40960
    v_mfma_f32_16x16x32_bf16 v[120:123], v[68:71], a[24:27], v[120:123]
    s_waitcnt vmcnt(5)
    ds_read_b128 a[128:131], v34 offset:0
    global_load_lds_dwordx4 v17, s[32:33] offset:0 sc1
    s_waitcnt lgkmcnt(8)
    v_mfma_f32_16x16x32_bf16 v[128:131], v[72:75], a[8:11], v[128:131]
    ds_read_b128 v[92:95], v1 offset:58368
    ds_read_b128 a[132:135], v35 offset:0
    v_mfma_f32_16x16x32_bf16 v[132:135], v[72:75], a[24:27], v[132:135]
    ds_read_b128 a[136:139], v36 offset:0
    ds_read_b128 a[140:143], v37 offset:0
    v_mfma_f32_16x16x32_bf16 v[140:143], v[76:79], a[8:11], v[140:143]
    ds_read_b128 v[96:99], v1 offset:59392
    ds_read_b128 a[144:147], v34 offset:4096
    v_mfma_f32_16x16x32_bf16 v[144:147], v[76:79], a[24:27], v[144:147]
    ds_read_b128 a[148:151], v35 offset:4096
    ds_read_b128 a[152:155], v36 offset:4096
    s_waitcnt lgkmcnt(12)
    v_mfma_f32_16x16x32_bf16 v[152:155], v[80:83], a[8:11], v[152:155]
    ds_read_b128 v[100:103], v1 offset:60416
    ds_read_b128 a[156:159], v37 offset:4096
    v_mfma_f32_16x16x32_bf16 v[156:159], v[80:83], a[24:27], v[156:159]
    s_waitcnt lgkmcnt(0)
    s_barrier
    v_mfma_f32_16x16x32_bf16 v[104:107], v[84:87], a[12:15], v[104:107]
    ds_read_b128 v[64:67], v38 offset:0
    v_mfma_f32_16x16x32_bf16 v[108:111], v[84:87], a[28:31], v[108:111]
    v_mfma_f32_16x16x32_bf16 v[116:119], v[88:91], a[12:15], v[116:119]
    ds_read_b128 v[68:71], v38 offset:1024
    s_add_u32 s18, s3, 3
    v_mfma_f32_16x16x32_bf16 v[120:123], v[88:91], a[28:31], v[120:123]
    s_sub_u32 s79, s18, 5
    s_cselect_b32 s18, s18, s79
    s_mul_i32 s18, s18, 20480
    s_add_u32 s18, s18, s17
    s_add_u32 s32, s36, s18
    s_addc_u32 s33, s37, 0
    s_add_u32 m0, s89, 0
    s_nop 0
    global_load_lds_dwordx4 v1, s[32:33] offset:0 sc1
    v_mfma_f32_16x16x32_bf16 v[128:131], v[92:95], a[12:15], v[128:131]
    ds_read_b128 v[72:75], v38 offset:2048
    v_mfma_f32_16x16x32_bf16 v[132:135], v[92:95], a[28:31], v[132:135]
    v_mfma_f32_16x16x32_bf16 v[140:143], v[96:99], a[12:15], v[140:143]
    ds_read_b128 v[76:79], v38 offset:3072
    global_load_lds_dwordx4 v1, s[32:33] offset:1024 sc1
    v_mfma_f32_16x16x32_bf16 v[144:147], v[96:99], a[28:31], v[144:147]
    v_mfma_f32_16x16x32_bf16 v[152:155], v[100:103], a[12:15], v[152:155]
    ds_read_b128 v[80:83], v38 offset:4096
    v_mfma_f32_16x16x32_bf16 v[156:159], v[100:103], a[28:31], v[156:159]
    global_load_lds_dwordx4 v1, s[32:33] offset:2048 sc1
    s_waitcnt lgkmcnt(3)
    v_mfma_f32_16x16x32_bf16 v[104:107], v[64:67], a[32:35], v[104:107]
    ds_read_b128 v[84:87], v38 offset:5120
    v_mfma_f32_16x16x32_bf16 v[108:111], v[64:67], a[48:51], v[108:111]
    v_mfma_f32_16x16x32_bf16 v[116:119], v[68:71], a[32:35], v[116:119]
    ds_read_b128 v[88:91], v38 offset:6144
    s_add_u32 m0, s90, 155648
    v_mfma_f32_16x16x32_bf16 v[120:123], v[68:71], a[48:51], v[120:123]
    buffer_load_dwordx4 v1, s[36:39], s91 offen offset:0 sc1 lds
    s_waitcnt lgkmcnt(3)
    v_mfma_f32_16x16x32_bf16 v[128:131], v[72:75], a[32:35], v[128:131]
    ds_read_b128 v[92:95], v38 offset:7168
    v_mfma_f32_16x16x32_bf16 v[132:135], v[72:75], a[48:51], v[132:135]
    v_mfma_f32_16x16x32_bf16 v[140:143], v[76:79], a[32:35], v[140:143]
    ds_read_b128 v[96:99], v38 offset:8192
    v_mfma_f32_16x16x32_bf16 v[144:147], v[76:79], a[48:51], v[144:147]
    buffer_load_dwordx4 v1, s[36:39], s91 offen offset:1024 sc1 lds
    s_waitcnt lgkmcnt(3)
    v_mfma_f32_16x16x32_bf16 v[152:155], v[80:83], a[32:35], v[152:155]
    ds_read_b128 v[100:103], v38 offset:9216
    v_mfma_f32_16x16x32_bf16 v[156:159], v[80:83], a[48:51], v[156:159]
    v_mfma_f32_16x16x32_bf16 v[104:107], v[84:87], a[36:39], v[104:107]
    ds_read_b128 v[64:67], v38 offset:10240
    v_mfma_f32_16x16x32_bf16 v[108:111], v[84:87], a[52:55], v[108:111]
    s_add_u32 m0, s89, 0
    s_waitcnt lgkmcnt(3)
    v_mfma_f32_16x16x32_bf16 v[116:119], v[88:91], a[36:39], v[116:119]
    ds_read_b128 v[68:71], v38 offset:11264
    global_load_lds_dwordx4 v1, s[32:33] offset:3072 sc1
    v_mfma_f32_16x16x32_bf16 v[120:123], v[88:91], a[52:55], v[120:123]
    v_mfma_f32_16x16x32_bf16 v[128:131], v[92:95], a[36:39], v[128:131]
    ds_read_b128 v[72:75], v38 offset:12288
    v_mfma_f32_16x16x32_bf16 v[132:135], v[92:95], a[52:55], v[132:135]
    s_add_u32 m0, s89, 4096
    s_waitcnt lgkmcnt(3)
    v_mfma_f32_16x16x32_bf16 v[140:143], v[96:99], a[36:39], v[140:143]
    ds_read_b128 v[76:79], v38 offset:13312
    global_load_lds_dwordx4 v17, s[32:33] offset:0 sc1
    v_mfma_f32_16x16x32_bf16 v[144:147], v[96:99], a[52:55], v[144:147]
    v_mfma_f32_16x16x32_bf16 v[152:155], v[100:103], a[36:39], v[152:155]
    ds_read_b128 v[80:83], v38 offset:14336
    s_add_u32 s18, s3, 4
    v_mfma_f32_16x16x32_bf16 v[156:159], v[100:103], a[52:55], v[156:159]
    s_sub_u32 s79, s18, 5
    s_cselect_b32 s18, s18, s79
    s_mul_i32 s18, s18, 20480
    s_add_u32 s18, s18, s17
    s_add_u32 s32, s36, s18
    s_addc_u32 s33, s37, 0
    s_add_u32 m0, s89, 20480
    s_nop 0
    global_load_lds_dwordx4 v1, s[32:33] offset:0 sc1
    s_waitcnt lgkmcnt(3)
    v_mfma_f32_16x16x32_bf16 v[104:107], v[64:67], a[40:43], v[104:107]
    ds_read_b128 v[84:87], v38 offset:15360
    v_mfma_f32_16x16x32_bf16 v[108:111], v[64:67], a[56:59], v[108:111]
    v_mfma_f32_16x16x32_bf16 v[116:119], v[68:71], a[40:43], v[116:119]
    ds_read_b128 v[88:91], v38 offset:16384
    v_mfma_f32_16x16x32_bf16 v[120:123], v[68:71], a[56:59], v[120:123]
    s_waitcnt lgkmcnt(3)
    v_mfma_f32_16x16x32_bf16 v[128:131], v[72:75], a[40:43], v[128:131]
    ds_read_b128 v[92:95], v38 offset:17408
    v_mfma_f32_16x16x32_bf16 v[132:135], v[72:75], a[56:59], v[132:135]
    global_load_lds_dwordx4 v1, s[32:33] offset:1024 sc1
    v_mfma_f32_16x16x32_bf16 v[140:143], v[76:79], a[40:43], v[140:143]
    ds_read_b128 v[96:99], v38 offset:18432
    v_mfma_f32_16x16x32_bf16 v[144:147], v[76:79], a[56:59], v[144:147]
    s_waitcnt lgkmcnt(3)
    v_mfma_f32_16x16x32_bf16 v[152:155], v[80:83], a[40:43], v[152:155]
    ds_read_b128 v[100:103], v38 offset:19456
    global_load_lds_dwordx4 v1, s[32:33] offset:2048 sc1
    v_mfma_f32_16x16x32_bf16 v[156:159], v[80:83], a[56:59], v[156:159]
    s_waitcnt vmcnt(10)
    s_waitcnt lgkmcnt(0)
    s_barrier
    s_lshl_b32 s72, s64, 11
    s_lshl_b32 s73, s65, 7
    s_add_u32 s72, s72, s73
    s_add_u32 s72, s72, 266240
    buffer_store_dwordx2 v[8:9], v5, s[36:39], s72 offen sc1
    v_mfma_f32_16x16x32_bf16 v[104:107], v[84:87], a[44:47], v[104:107]
    ds_read_b128 v[64:67], v38 offset:20480
    v_mfma_f32_16x16x32_bf16 v[108:111], v[84:87], a[60:63], v[108:111]
    v_mfma_f32_16x16x32_bf16 v[116:119], v[88:91], a[44:47], v[116:119]
    ds_read_b128 v[68:71], v38 offset:21504
    v_mfma_f32_16x16x32_bf16 v[120:123], v[88:91], a[60:63], v[120:123]
    v_mfma_f32_16x16x32_bf16 v[128:131], v[92:95], a[44:47], v[128:131]
    ds_read_b128 v[72:75], v38 offset:22528
    global_load_lds_dwordx4 v1, s[32:33] offset:3072 sc1
    v_mfma_f32_16x16x32_bf16 v[132:135], v[92:95], a[60:63], v[132:135]
    v_mfma_f32_16x16x32_bf16 v[140:143], v[96:99], a[44:47], v[140:143]
    ds_read_b128 v[76:79], v38 offset:23552
    v_mfma_f32_16x16x32_bf16 v[144:147], v[96:99], a[60:63], v[144:147]
    s_add_u32 m0, s89, 24576
    v_mfma_f32_16x16x32_bf16 v[152:155], v[100:103], a[44:47], v[152:155]
    ds_read_b128 v[80:83], v38 offset:24576
    global_load_lds_dwordx4 v17, s[32:33] offset:0 sc1
    v_mfma_f32_16x16x32_bf16 v[156:159], v[100:103], a[60:63], v[156:159]
    s_waitcnt lgkmcnt(3)
    v_mfma_f32_16x16x32_bf16 v[104:107], v[64:67], a[64:67], v[104:107]
    ds_read_b128 v[84:87], v38 offset:25600
    v_mfma_f32_16x16x32_bf16 v[108:111], v[64:67], a[80:83], v[108:111]
    v_mfma_f32_16x16x32_bf16 v[116:119], v[68:71], a[64:67], v[116:119]
    ds_read_b128 v[88:91], v38 offset:26624
    s_add_u32 s20, s3, 0
    v_mfma_f32_16x16x32_bf16 v[120:123], v[68:71], a[80:83], v[120:123]
    s_sub_u32 s79, s20, 5
    s_cselect_b32 s20, s20, s79
    s_mul_i32 s20, s20, 12288
    s_add_u32 s20, s20, s19
    s_add_u32 s34, s36, s20
    s_addc_u32 s35, s37, 0
    s_add_u32 m0, s88, 102400
    s_nop 0
    global_load_lds_dwordx4 v1, s[34:35] offset:0 sc1
    s_waitcnt lgkmcnt(3)
    v_mfma_f32_16x16x32_bf16 v[128:131], v[72:75], a[64:67], v[128:131]
    ds_read_b128 v[92:95], v38 offset:27648
    v_mfma_f32_16x16x32_bf16 v[132:135], v[72:75], a[80:83], v[132:135]
    v_mfma_f32_16x16x32_bf16 v[140:143], v[76:79], a[64:67], v[140:143]
    ds_read_b128 v[96:99], v38 offset:28672
    v_mfma_f32_16x16x32_bf16 v[144:147], v[76:79], a[80:83], v[144:147]
    global_load_lds_dwordx4 v1, s[34:35] offset:1024 sc1
    s_waitcnt lgkmcnt(3)
    v_mfma_f32_16x16x32_bf16 v[152:155], v[80:83], a[64:67], v[152:155]
    ds_read_b128 v[100:103], v38 offset:29696
    v_mfma_f32_16x16x32_bf16 v[156:159], v[80:83], a[80:83], v[156:159]
    v_bfe_u32 v22, v16, 4, 1
    v_mfma_f32_16x16x32_bf16 v[104:107], v[84:87], a[68:71], v[104:107]
    ds_read_b128 v[64:67], v38 offset:30720
    v_lshl_add_u32 v22, v22, 7, v7
    v_mfma_f32_16x16x32_bf16 v[108:111], v[84:87], a[84:87], v[108:111]
    s_lshl_b32 s26, s68, 8
    s_add_u32 s26, s26, 4096
    s_lshl_b32 s27, s66, 7
    s_add_u32 s27, s27, 36864
    v_and_b32 v32, 1, v2
    s_waitcnt lgkmcnt(3)
    v_mfma_f32_16x16x32_bf16 v[116:119], v[88:91], a[68:71], v[116:119]
    ds_read_b128 v[68:71], v38 offset:31744
    global_load_lds_dwordx4 v1, s[34:35] offset:2048 sc1
    v_mfma_f32_16x16x32_bf16 v[120:123], v[88:91], a[84:87], v[120:123]
    v_mfma_f32_16x16x32_bf16 v[128:131], v[92:95], a[68:71], v[128:131]
    ds_read_b128 v[72:75], v38 offset:32768
    s_add_u32 s20, s3, 1
    v_mfma_f32_16x16x32_bf16 v[132:135], v[92:95], a[84:87], v[132:135]
    s_sub_u32 s79, s20, 5
    s_cselect_b32 s20, s20, s79
    s_mul_i32 s20, s20, 12288
    s_add_u32 s20, s20, s19
    s_add_u32 s34, s36, s20
    s_addc_u32 s35, s37, 0
    s_add_u32 m0, s88, 114688
    s_nop 0
    global_load_lds_dwordx4 v1, s[34:35] offset:0 sc1
    s_waitcnt lgkmcnt(3)
    v_mfma_f32_16x16x32_bf16 v[140:143], v[96:99], a[68:71], v[140:143]
    ds_read_b128 v[76:79], v38 offset:33792
    v_mfma_f32_16x16x32_bf16 v[144:147], v[96:99], a[84:87], v[144:147]
    v_mfma_f32_16x16x32_bf16 v[152:155], v[100:103], a[68:71], v[152:155]
    ds_read_b128 v[80:83], v38 offset:34816
    v_mul_u32_u24 v32, 1856, v32
    v_mfma_f32_16x16x32_bf16 v[156:159], v[100:103], a[84:87], v[156:159]
    s_lshl_b32 s22, s67, 12
    s_mul_i32 s21, s68, 102400
    s_add_u32 s21, s21, 16777216
    v_lshl_add_u32 v32, v15, 4, v32
    s_waitcnt lgkmcnt(3)
    v_mfma_f32_16x16x32_bf16 v[104:107], v[64:67], a[72:75], v[104:107]
    ds_read_b128 v[84:87], v38 offset:35840
    global_load_lds_dwordx4 v1, s[34:35] offset:1024 sc1
    v_mfma_f32_16x16x32_bf16 v[108:111], v[64:67], a[88:91], v[108:111]
    v_mfma_f32_16x16x32_bf16 v[116:119], v[68:71], a[72:75], v[116:119]
    ds_read_b128 v[88:91], v38 offset:36864
    v_mfma_f32_16x16x32_bf16 v[120:123], v[68:71], a[88:91], v[120:123]
    s_mul_i32 s24, s65, 245760
    s_mul_i32 s83, s67, 61440
    s_add_u32 s24, s24, s83
    v_mov_b32 v12, 4224
    s_waitcnt lgkmcnt(3)
    v_mfma_f32_16x16x32_bf16 v[128:131], v[72:75], a[72:75], v[128:131]
    ds_read_b128 v[92:95], v38 offset:37888
    global_load_lds_dwordx4 v1, s[34:35] offset:2048 sc1
    v_mfma_f32_16x16x32_bf16 v[132:135], v[72:75], a[88:91], v[132:135]
    s_add_u32 s24, s24, 17825792
    v_cmp_eq_u32 vcc, v14, v2
    v_mfma_f32_16x16x32_bf16 v[140:143], v[76:79], a[72:75], v[140:143]
    ds_read_b128 v[96:99], v38 offset:38912
    s_add_u32 s20, s3, 2
    v_mfma_f32_16x16x32_bf16 v[144:147], v[76:79], a[88:91], v[144:147]
    s_sub_u32 s79, s20, 5
    s_cselect_b32 s20, s20, s79
    s_mul_i32 s20, s20, 12288
    s_add_u32 s20, s20, s19
    s_add_u32 s34, s36, s20
    s_addc_u32 s35, s37, 0
    s_add_u32 m0, s88, 126976
    s_nop 0
    global_load_lds_dwordx4 v1, s[34:35] offset:0 sc1
    s_waitcnt lgkmcnt(3)
    v_mfma_f32_16x16x32_bf16 v[152:155], v[80:83], a[72:75], v[152:155]
    ds_read_b128 v[100:103], v38 offset:39936
    v_mfma_f32_16x16x32_bf16 v[156:159], v[80:83], a[88:91], v[156:159]
    s_waitcnt vmcnt(13)
    s_waitcnt lgkmcnt(0)
    s_barrier
    v_mfma_f32_16x16x32_bf16 v[104:107], v[84:87], a[76:79], v[104:107]
    ds_read_b128 v[64:67], v1 offset:0
    v_mfma_f32_16x16x32_bf16 v[108:111], v[84:87], a[92:95], v[108:111]
    s_mul_i32 s84, s66, 57344
    s_add_u32 s84, s84, 524288
    v_lshlrev_b32 v31, 4, v0
    v_mfma_f32_16x16x32_bf16 v[116:119], v[88:91], a[76:79], v[116:119]
    ds_read_b128 v[68:71], v1 offset:1024
    v_mfma_f32_16x16x32_bf16 v[120:123], v[88:91], a[92:95], v[120:123]
    global_load_lds_dwordx4 v1, s[34:35] offset:1024 sc1
    global_load_lds_dwordx4 v1, s[34:35] offset:2048 sc1
    v_mfma_f32_16x16x32_bf16 v[128:131], v[92:95], a[76:79], v[128:131]
    ds_read_b128 v[72:75], v1 offset:2048
    v_cndmask_b32 v32, v12, v32, vcc
    v_mfma_f32_16x16x32_bf16 v[132:135], v[92:95], a[92:95], v[132:135]
    v_mov_b32 v12, 1073741824
    v_cmp_gt_u32 vcc, 224, v0
    v_mfma_f32_16x16x32_bf16 v[140:143], v[96:99], a[76:79], v[140:143]
    ds_read_b128 v[76:79], v1 offset:3072
    v_add_u32 v32, 102400, v32
    v_mfma_f32_16x16x32_bf16 v[144:147], v[96:99], a[92:95], v[144:147]
    v_cndmask_b32 v30, v12, v31, vcc
    v_cmp_lt_u32 vcc, 111, v0
    v_mfma_f32_16x16x32_bf16 v[152:155], v[100:103], a[76:79], v[152:155]
    ds_read_b128 v[80:83], v1 offset:4096
    v_add_u32 v31, 102400, v31
    v_mfma_f32_16x16x32_bf16 v[156:159], v[100:103], a[92:95], v[156:159]
    s_waitcnt lgkmcnt(3)
    v_add_u32 v12, 64, v31
    v_cndmask_b32 v31, v31, v12, vcc
    v_mfma_f32_16x16x32_bf16 v[104:107], v[64:67], a[96:99], v[104:107]
    ds_read_b128 v[84:87], v1 offset:5120
    s_add_u32 s20, s3, 3
    v_mfma_f32_16x16x32_bf16 v[108:111], v[64:67], a[112:115], v[108:111]
    s_sub_u32 s79, s20, 5
    s_cselect_b32 s20, s20, s79
    s_mul_i32 s20, s20, 12288
    s_add_u32 s20, s20, s19
    s_add_u32 s34, s36, s20
    s_addc_u32 s35, s37, 0
    s_add_u32 m0, s88, 139264
    s_nop 0
    global_load_lds_dwordx4 v1, s[34:35] offset:0 sc1
    v_mfma_f32_16x16x32_bf16 v[116:119], v[68:71], a[96:99], v[116:119]
    ds_read_b128 v[88:91], v1 offset:6144
    v_mfma_f32_16x16x32_bf16 v[120:123], v[68:71], a[112:115], v[120:123]
    s_waitcnt lgkmcnt(3)
    v_mfma_f32_16x16x32_bf16 v[128:131], v[72:75], a[96:99], v[128:131]
    ds_read_b128 v[92:95], v1 offset:7168
    v_mfma_f32_16x16x32_bf16 v[132:135], v[72:75], a[112:115], v[132:135]
    v_mfma_f32_16x16x32_bf16 v[140:143], v[76:79], a[96:99], v[140:143]
    ds_read_b128 v[96:99], v1 offset:8192
    global_load_lds_dwordx4 v1, s[34:35] offset:1024 sc1
    v_mfma_f32_16x16x32_bf16 v[144:147], v[76:79], a[112:115], v[144:147]
    s_waitcnt lgkmcnt(3)
    v_mfma_f32_16x16x32_bf16 v[152:155], v[80:83], a[96:99], v[152:155]
    ds_read_b128 v[100:103], v1 offset:9216
    v_mfma_f32_16x16x32_bf16 v[156:159], v[80:83], a[112:115], v[156:159]
    v_mfma_f32_16x16x32_bf16 v[104:107], v[84:87], a[100:103], v[104:107]
    ds_read_b128 v[64:67], v1 offset:10240
    global_load_lds_dwordx4 v1, s[34:35] offset:2048 sc1
    v_mfma_f32_16x16x32_bf16 v[108:111], v[84:87], a[116:119], v[108:111]
    s_waitcnt lgkmcnt(3)
    v_add_u32 v11, 155648, v1
    v_mfma_f32_16x16x32_bf16 v[116:119], v[88:91], a[100:103], v[116:119]
    ds_read_b128 v[68:71], v1 offset:11264
    s_add_u32 s91, s26, 262144
    v_mfma_f32_16x16x32_bf16 v[120:123], v[88:91], a[116:119], v[120:123]
    buffer_load_dwordx2 v[24:25], v22, s[36:39], s91 offen sc1
    v_mfma_f32_16x16x32_bf16 v[128:131], v[92:95], a[100:103], v[128:131]
    ds_read_b128 v[72:75], v1 offset:12288
    ds_read_b128 v[188:191], v11 offset:0
    v_mfma_f32_16x16x32_bf16 v[132:135], v[92:95], a[116:119], v[132:135]
    s_lshl_b32 s25, s64, 11
    s_lshl_b32 s75, s67, 9
    s_add_u32 s25, s25, s75
    s_add_u32 s25, s25, 30408704
    v_lshlrev_b32 v172, 4, v3
    buffer_load_dwordx4 v[164:167], v172, s[36:39], s25 offen offset:0 sc1
    s_waitcnt lgkmcnt(4)
    v_mfma_f32_16x16x32_bf16 v[140:143], v[96:99], a[100:103], v[140:143]
    ds_read_b128 v[76:79], v1 offset:13312
    ds_read_b128 v[192:195], v11 offset:1024
    v_mfma_f32_16x16x32_bf16 v[144:147], v[96:99], a[116:119], v[144:147]
    buffer_load_dwordx4 v[168:171], v172, s[36:39], s25 offen offset:256 sc1
    v_mfma_f32_16x16x32_bf16 v[152:155], v[100:103], a[100:103], v[152:155]
    ds_read_b128 v[80:83], v1 offset:14336
    ds_read_b128 v[196:199], v11 offset:2048
    v_mfma_f32_16x16x32_bf16 v[156:159], v[100:103], a[116:119], v[156:159]
    ds_read_b128 v[200:203], v11 offset:3072
    ds_read_b128 v[204:207], v11 offset:4096
    s_waitcnt lgkmcnt(8)
    v_mfma_f32_16x16x32_bf16 v[104:107], v[64:67], a[104:107], v[104:107]
    ds_read_b128 v[84:87], v1 offset:15360
    s_lshl_b32 s90, s67, 11
    v_mfma_f32_16x16x32_bf16 v[108:111], v[64:67], a[120:123], v[108:111]
    s_mul_i32 s99, s64, 122880
    s_mul_i32 s100, s65, 192
    v_mfma_f32_16x16x32_bf16 v[116:119], v[68:71], a[104:107], v[116:119]
    ds_read_b128 v[88:91], v1 offset:16384
    s_add_u32 s99, s99, s100
    s_add_u32 m0, s90, 40960
    v_mfma_f32_16x16x32_bf16 v[120:123], v[68:71], a[120:123], v[120:123]
    buffer_load_dwordx4 v26, s[40:43], s99 offen nt lds
    s_waitcnt lgkmcnt(6)
    v_mfma_f32_16x16x32_bf16 v[128:131], v[72:75], a[104:107], v[128:131]
    ds_read_b128 v[92:95], v1 offset:17408
    s_add_u32 m0, s90, 41984
    v_mfma_f32_16x16x32_bf16 v[132:135], v[72:75], a[120:123], v[132:135]
    buffer_load_dwordx4 v27, s[40:43], s99 offen nt lds
    v_mfma_f32_16x16x32_bf16 v[140:143], v[76:79], a[104:107], v[140:143]
    ds_read_b128 v[96:99], v1 offset:18432
    ds_read_b128 a[240:243], v11 offset:5120
    v_mfma_f32_16x16x32_bf16 v[144:147], v[76:79], a[120:123], v[144:147]
    ds_read_b128 a[244:247], v11 offset:6144
    ds_read_b128 a[248:251], v11 offset:7168
    s_waitcnt lgkmcnt(6)
    v_mfma_f32_16x16x32_bf16 v[152:155], v[80:83], a[104:107], v[152:155]
    ds_read_b128 v[100:103], v1 offset:19456
    s_lshl_b32 s90, s67, 11
    v_mfma_f32_16x16x32_bf16 v[156:159], v[80:83], a[120:123], v[156:159]
    s_waitcnt vmcnt(17)
    s_waitcnt lgkmcnt(0)
    s_barrier
    v_mfma_f32_16x16x32_bf16 v[104:107], v[84:87], a[108:111], v[104:107]
    ds_read_b128 v[64:67], v1 offset:20480
    s_mul_i32 s99, s64, 122880
    v_mfma_f32_16x16x32_bf16 v[108:111], v[84:87], a[124:127], v[108:111]
    s_mul_i32 s100, s65, 192
    s_add_u32 s99, s99, s100
    v_mfma_f32_16x16x32_bf16 v[116:119], v[88:91], a[108:111], v[116:119]
    ds_read_b128 v[68:71], v1 offset:21504
    s_add_u32 m0, s90, 49152
    v_mfma_f32_16x16x32_bf16 v[120:123], v[88:91], a[124:127], v[120:123]
    buffer_load_dwordx4 v26, s[44:47], s99 offen nt lds
    v_mfma_f32_16x16x32_bf16 v[128:131], v[92:95], a[108:111], v[128:131]
    ds_read_b128 v[72:75], v1 offset:22528
    v_mfma_f32_16x16x32_bf16 v[132:135], v[92:95], a[124:127], v[132:135]
    v_mfma_f32_16x16x32_bf16 v[140:143], v[96:99], a[108:111], v[140:143]
    ds_read_b128 v[76:79], v1 offset:23552
    s_add_u32 m0, s90, 50176
    v_mfma_f32_16x16x32_bf16 v[144:147], v[96:99], a[124:127], v[144:147]
    buffer_load_dwordx4 v27, s[44:47], s99 offen nt lds
    v_mfma_f32_16x16x32_bf16 v[152:155], v[100:103], a[108:111], v[152:155]
    ds_read_b128 v[80:83], v1 offset:24576
    v_mfma_f32_16x16x32_bf16 v[156:159], v[100:103], a[124:127], v[156:159]
    s_waitcnt lgkmcnt(3)
    v_mfma_f32_16x16x32_bf16 v[104:107], v[64:67], a[128:131], v[104:107]
    ds_read_b128 v[84:87], v1 offset:25600
    s_lshl_b32 s90, s67, 11
    v_mfma_f32_16x16x32_bf16 v[108:111], v[64:67], a[144:147], v[108:111]
    s_lshl_b32 s99, s64, 1
    s_add_u32 s99, s99, s69
    v_mfma_f32_16x16x32_bf16 v[116:119], v[68:71], a[128:131], v[116:119]
    ds_read_b128 v[88:91], v1 offset:26624
    s_mul_i32 s99, s99, 61440
    v_mfma_f32_16x16x32_bf16 v[120:123], v[68:71], a[144:147], v[120:123]
    s_mul_i32 s100, s68, 160
    s_add_u32 s99, s99, s100
    s_add_u32 m0, s90, 57344
    s_nop 0
    buffer_load_dwordx4 v28, s[48:51], s99 offen nt lds
    s_waitcnt lgkmcnt(3)
    v_mfma_f32_16x16x32_bf16 v[128:131], v[72:75], a[128:131], v[128:131]
    ds_read_b128 v[92:95], v1 offset:27648
    v_mfma_f32_16x16x32_bf16 v[132:135], v[72:75], a[144:147], v[132:135]
    v_mfma_f32_16x16x32_bf16 v[140:143], v[76:79], a[128:131], v[140:143]
    ds_read_b128 v[96:99], v1 offset:28672
    s_add_u32 m0, s90, 58368
    v_mfma_f32_16x16x32_bf16 v[144:147], v[76:79], a[144:147], v[144:147]
    buffer_load_dwordx4 v29, s[48:51], s99 offen nt lds
    s_waitcnt lgkmcnt(3)
    v_mfma_f32_16x16x32_bf16 v[152:155], v[80:83], a[128:131], v[152:155]
    ds_read_b128 v[100:103], v1 offset:29696
    v_mfma_f32_16x16x32_bf16 v[156:159], v[80:83], a[144:147], v[156:159]
    v_mfma_f32_16x16x32_bf16 v[104:107], v[84:87], a[132:135], v[104:107]
    ds_read_b128 v[64:67], v1 offset:30720
    v_mfma_f32_16x16x32_bf16 v[108:111], v[84:87], a[148:151], v[108:111]
    s_waitcnt lgkmcnt(3)
    v_mfma_f32_16x16x32_bf16 v[116:119], v[88:91], a[132:135], v[116:119]
    ds_read_b128 v[68:71], v1 offset:31744
    v_mfma_f32_16x16x32_bf16 v[120:123], v[88:91], a[148:151], v[120:123]
    v_mfma_f32_16x16x32_bf16 v[128:131], v[92:95], a[132:135], v[128:131]
    ds_read_b128 v[72:75], v1 offset:32768
    v_mfma_f32_16x16x32_bf16 v[132:135], v[92:95], a[148:151], v[132:135]
    s_waitcnt lgkmcnt(3)
    v_mfma_f32_16x16x32_bf16 v[140:143], v[96:99], a[132:135], v[140:143]
    ds_read_b128 v[76:79], v1 offset:33792
    v_mfma_f32_16x16x32_bf16 v[144:147], v[96:99], a[148:151], v[144:147]
    v_mfma_f32_16x16x32_bf16 v[152:155], v[100:103], a[132:135], v[152:155]
    ds_read_b128 v[80:83], v1 offset:34816
    v_mfma_f32_16x16x32_bf16 v[156:159], v[100:103], a[148:151], v[156:159]
    s_waitcnt lgkmcnt(3)
    v_mfma_f32_16x16x32_bf16 v[104:107], v[64:67], a[136:139], v[104:107]
    ds_read_b128 v[84:87], v1 offset:35840
    v_mfma_f32_16x16x32_bf16 v[108:111], v[64:67], a[152:155], v[108:111]
    v_mfma_f32_16x16x32_bf16 v[116:119], v[68:71], a[136:139], v[116:119]
    ds_read_b128 v[88:91], v1 offset:36864
    v_mfma_f32_16x16x32_bf16 v[120:123], v[68:71], a[152:155], v[120:123]
    s_waitcnt lgkmcnt(3)
    v_mfma_f32_16x16x32_bf16 v[128:131], v[72:75], a[136:139], v[128:131]
    ds_read_b128 v[92:95], v1 offset:37888
    v_mfma_f32_16x16x32_bf16 v[132:135], v[72:75], a[152:155], v[132:135]
    v_mfma_f32_16x16x32_bf16 v[140:143], v[76:79], a[136:139], v[140:143]
    ds_read_b128 v[96:99], v1 offset:38912
    v_mfma_f32_16x16x32_bf16 v[144:147], v[76:79], a[152:155], v[144:147]
    s_waitcnt lgkmcnt(3)
    v_mfma_f32_16x16x32_bf16 v[152:155], v[80:83], a[136:139], v[152:155]
    ds_read_b128 v[100:103], v1 offset:39936
    v_mfma_f32_16x16x32_bf16 v[156:159], v[80:83], a[152:155], v[156:159]
    v_mfma_f32_16x16x32_bf16 v[104:107], v[84:87], a[140:143], v[104:107]
    v_mfma_f32_16x16x32_bf16 v[108:111], v[84:87], a[156:159], v[108:111]
    s_waitcnt lgkmcnt(2)
    v_mfma_f32_16x16x32_bf16 v[116:119], v[88:91], a[140:143], v[116:119]
    v_mfma_f32_16x16x32_bf16 v[120:123], v[88:91], a[156:159], v[120:123]
    v_mfma_f32_16x16x32_bf16 v[128:131], v[92:95], a[140:143], v[128:131]
    v_mfma_f32_16x16x32_bf16 v[132:135], v[92:95], a[156:159], v[132:135]
    s_waitcnt lgkmcnt(0)
    v_mfma_f32_16x16x32_bf16 v[140:143], v[96:99], a[140:143], v[140:143]
    v_mfma_f32_16x16x32_bf16 v[144:147], v[96:99], a[156:159], v[144:147]
    v_mfma_f32_16x16x32_bf16 v[152:155], v[100:103], a[140:143], v[152:155]
    v_mfma_f32_16x16x32_bf16 v[156:159], v[100:103], a[156:159], v[156:159]
    v_mfma_f32_16x16x32_bf16 v[112:115], v[188:191], v[60:63], 0
    v_mfma_f32_16x16x32_bf16 v[124:127], v[192:195], v[60:63], 0
    v_mfma_f32_16x16x32_bf16 v[136:139], v[196:199], v[60:63], 0
    s_waitcnt vmcnt(6)
    s_mov_b32 s95, 100000
L_sc:
    v_cmp_ne_u32 vcc, s70, v165
    v_cmp_ne_u32 s[76:77], s70, v169
    s_or_b64 vcc, vcc, s[76:77]
    v_cmp_ne_u32 s[76:77], s86, v167
    s_or_b64 vcc, vcc, s[76:77]
    v_cmp_ne_u32 s[76:77], s86, v171
    s_or_b64 vcc, vcc, s[76:77]
    s_cbranch_scc0 L_sd
    buffer_load_dwordx4 v[164:167], v172, s[36:39], s25 offen sc1
    buffer_load_dwordx4 v[168:171], v172, s[36:39], s25 offen offset:256 sc1
    s_waitcnt vmcnt(0)
    s_sub_u32 s95, s95, 1
    s_cbranch_scc0 L_sc
L_sd:
    v_mfma_f32_16x16x32_bf16 v[148:151], v[200:203], v[60:63], 0
    v_mov_b32 v180, v164
    v_mov_b32 v181, v166
    v_mfma_f32_16x16x32_bf16 v[160:163], v[204:207], v[60:63], 0
    v_mov_b32 v182, v168
    v_mov_b32 v183, v170
    v_pk_fma_f32 v[104:105], v[112:113], v[180:181], v[104:105] op_sel_hi:[1,0,1]
    v_pk_fma_f32 v[106:107], v[114:115], v[180:181], v[106:107] op_sel_hi:[1,0,1]
    v_pk_mul_f32 v[104:105], v[104:105], v[180:181] op_sel:[0,1] op_sel_hi:[1,1]
    v_pk_mul_f32 v[106:107], v[106:107], v[180:181] op_sel:[0,1] op_sel_hi:[1,1]
    v_cvt_pk_bf16_f32 v188, v104, v105
    v_cvt_pk_bf16_f32 v189, v106, v107
    v_pk_fma_f32 v[116:117], v[124:125], v[180:181], v[116:117] op_sel_hi:[1,0,1]
    v_pk_fma_f32 v[118:119], v[126:127], v[180:181], v[118:119] op_sel_hi:[1,0,1]
    v_pk_mul_f32 v[116:117], v[116:117], v[180:181] op_sel:[0,1] op_sel_hi:[1,1]
    v_pk_mul_f32 v[118:119], v[118:119], v[180:181] op_sel:[0,1] op_sel_hi:[1,1]
    v_cvt_pk_bf16_f32 v190, v116, v117
    v_cvt_pk_bf16_f32 v191, v118, v119
    v_pk_fma_f32 v[128:129], v[136:137], v[180:181], v[128:129] op_sel_hi:[1,0,1]
    v_pk_fma_f32 v[130:131], v[138:139], v[180:181], v[130:131] op_sel_hi:[1,0,1]
    v_pk_mul_f32 v[128:129], v[128:129], v[180:181] op_sel:[0,1] op_sel_hi:[1,1]
    v_pk_mul_f32 v[130:131], v[130:131], v[180:181] op_sel:[0,1] op_sel_hi:[1,1]
    v_cvt_pk_bf16_f32 v192, v128, v129
    v_cvt_pk_bf16_f32 v193, v130, v131
    v_pk_fma_f32 v[108:109], v[112:113], v[182:183], v[108:109] op_sel_hi:[1,0,1]
    v_pk_fma_f32 v[110:111], v[114:115], v[182:183], v[110:111] op_sel_hi:[1,0,1]
    v_pk_mul_f32 v[108:109], v[108:109], v[182:183] op_sel:[0,1] op_sel_hi:[1,1]
    v_pk_mul_f32 v[110:111], v[110:111], v[182:183] op_sel:[0,1] op_sel_hi:[1,1]
    v_cvt_pk_bf16_f32 v194, v108, v109
    v_cvt_pk_bf16_f32 v195, v110, v111
    v_pk_fma_f32 v[120:121], v[124:125], v[182:183], v[120:121] op_sel_hi:[1,0,1]
    v_pk_fma_f32 v[122:123], v[126:127], v[182:183], v[122:123] op_sel_hi:[1,0,1]
    v_pk_mul_f32 v[120:121], v[120:121], v[182:183] op_sel:[0,1] op_sel_hi:[1,1]
    v_pk_mul_f32 v[122:123], v[122:123], v[182:183] op_sel:[0,1] op_sel_hi:[1,1]
    v_cvt_pk_bf16_f32 v196, v120, v121
    v_cvt_pk_bf16_f32 v197, v122, v123
    v_pk_fma_f32 v[132:133], v[136:137], v[182:183], v[132:133] op_sel_hi:[1,0,1]
    v_pk_fma_f32 v[134:135], v[138:139], v[182:183], v[134:135] op_sel_hi:[1,0,1]
    v_pk_mul_f32 v[132:133], v[132:133], v[182:183] op_sel:[0,1] op_sel_hi:[1,1]
    v_pk_mul_f32 v[134:135], v[134:135], v[182:183] op_sel:[0,1] op_sel_hi:[1,1]
    v_cvt_pk_bf16_f32 v198, v132, v133
    v_cvt_pk_bf16_f32 v199, v134, v135
    v_mfma_f32_16x16x32_bf16 v[200:203], a[160:163], v[188:191], 0
    v_cmp_lt_u32 vcc, 1, v2
    v_mov_b32 v12, 16256
    v_mfma_f32_16x16x32_bf16 v[204:207], a[168:171], v[188:191], 0
    v_cndmask_b32 v94, v12, v190, vcc
    v_cndmask_b32 v95, 0, v191, vcc
    v_mfma_f32_16x16x32_bf16 v[208:211], a[176:179], v[188:191], 0
    ds_write_b64 v249, v[94:95] offset:200
    v_cndmask_b32 v96, v12, v196, vcc
    v_cndmask_b32 v97, 0, v197, vcc
    v_mfma_f32_16x16x32_bf16 v[212:215], a[184:187], v[188:191], 0
    ds_write_b64 v249, v[96:97] offset:4808
    v_fmac_f32 v140, v148, v180
    v_mfma_f32_16x16x32_bf16 v[216:219], a[192:195], v[188:191], 0
    v_fmac_f32 v141, v149, v180
    v_fmac_f32 v142, v150, v180
    v_fmac_f32 v143, v151, v180
    v_mfma_f32_16x16x32_bf16 v[200:203], a[164:167], v[190:193], v[200:203]
    v_mul_f32 v140, v140, v181
    v_mul_f32 v141, v141, v181
    v_mul_f32 v142, v142, v181
    v_mfma_f32_16x16x32_bf16 v[204:207], a[172:175], v[190:193], v[204:207]
    v_mul_f32 v143, v143, v181
    v_cvt_pk_bf16_f32 v84, v140, v141
    v_cvt_pk_bf16_f32 v85, v142, v143
    v_mfma_f32_16x16x32_bf16 v[208:211], a[180:183], v[190:193], v[208:211]
    ds_write_b64 v248, v[84:85] offset:160
    v_fmac_f32 v152, v160, v180
    v_mfma_f32_16x16x32_bf16 v[212:215], a[188:191], v[190:193], v[212:215]
    v_fmac_f32 v153, v161, v180
    v_fmac_f32 v154, v162, v180
    v_fmac_f32 v155, v163, v180
    v_mfma_f32_16x16x32_bf16 v[216:219], a[196:199], v[190:193], v[216:219]
    v_mul_f32 v152, v152, v181
    v_mul_f32 v153, v153, v181
    v_mul_f32 v154, v154, v181
    v_mfma_f32_16x16x32_bf16 v[200:203], a[200:203], v[194:197], v[200:203]
    v_mul_f32 v155, v155, v181
    v_cvt_pk_bf16_f32 v86, v152, v153
    v_cvt_pk_bf16_f32 v87, v154, v155
    v_mfma_f32_16x16x32_bf16 v[204:207], a[208:211], v[194:197], v[204:207]
    ds_write_b64 v248, v[86:87] offset:208
    v_fmac_f32 v144, v148, v182
    v_mfma_f32_16x16x32_bf16 v[208:211], a[216:219], v[194:197], v[208:211]
    v_fmac_f32 v145, v149, v182
    v_fmac_f32 v146, v150, v182
    v_fmac_f32 v147, v151, v182
    v_mfma_f32_16x16x32_bf16 v[212:215], a[224:227], v[194:197], v[212:215]
    v_mul_f32 v144, v144, v183
    v_mul_f32 v145, v145, v183
    v_mul_f32 v146, v146, v183
    v_mfma_f32_16x16x32_bf16 v[216:219], a[232:235], v[194:197], v[216:219]
    v_mul_f32 v147, v147, v183
    v_cvt_pk_bf16_f32 v88, v144, v145
    v_cvt_pk_bf16_f32 v89, v146, v147
    v_mfma_f32_16x16x32_bf16 v[200:203], a[204:207], v[196:199], v[200:203]
    ds_write_b64 v248, v[88:89] offset:4768
    v_fmac_f32 v156, v160, v182
    v_mfma_f32_16x16x32_bf16 v[204:207], a[212:215], v[196:199], v[204:207]
    v_fmac_f32 v157, v161, v182
    v_fmac_f32 v158, v162, v182
    v_fmac_f32 v159, v163, v182
    v_mfma_f32_16x16x32_bf16 v[208:211], a[220:223], v[196:199], v[208:211]
    v_mul_f32 v156, v156, v183
    v_mul_f32 v157, v157, v183
    v_mul_f32 v158, v158, v183
    v_mfma_f32_16x16x32_bf16 v[212:215], a[228:231], v[196:199], v[212:215]
    v_mul_f32 v159, v159, v183
    v_cvt_pk_bf16_f32 v90, v156, v157
    v_cvt_pk_bf16_f32 v91, v158, v159
    v_mfma_f32_16x16x32_bf16 v[216:219], a[236:239], v[196:199], v[216:219]
    ds_write_b64 v248, v[90:91] offset:4816
    v_max3_f32 v240, v200, v201, v202
    v_min3_f32 v241, v200, v201, v202
    v_max3_f32 v240, v240, v203, v204
    v_min3_f32 v241, v241, v203, v204
    v_max3_f32 v240, v240, v205, v206
    v_min3_f32 v241, v241, v205, v206
    v_max3_f32 v240, v240, v207, v208
    v_min3_f32 v241, v241, v207, v208
    v_max3_f32 v240, v240, v209, v210
    v_min3_f32 v241, v241, v209, v210
    v_max3_f32 v240, v240, v211, v212
    v_min3_f32 v241, v241, v211, v212
    v_max3_f32 v240, v240, v213, v214
    v_min3_f32 v241, v241, v213, v214
    v_max3_f32 v240, v240, v215, v216
    v_min3_f32 v241, v241, v215, v216
    v_max3_f32 v240, v240, v217, v218
    v_min3_f32 v241, v241, v217, v218
    v_max_f32 v240, v240, v219
    v_min_f32 v241, v241, v219
    v_mul_f32 v240, s11, v240
    v_mul_f32 v241, s10, v241
    v_pk_fma_f32 v[104:105], v[200:201], s[10:11], v[240:241] op_sel_hi:[1,0,0]
    v_pk_fma_f32 v[200:201], v[200:201], s[10:11], v[240:241] op_sel:[0,1,1] op_sel_hi:[1,1,1]
    v_pk_fma_f32 v[106:107], v[202:203], s[10:11], v[240:241] op_sel_hi:[1,0,0]
    v_pk_fma_f32 v[202:203], v[202:203], s[10:11], v[240:241] op_sel:[0,1,1] op_sel_hi:[1,1,1]
    v_pk_fma_f32 v[108:109], v[204:205], s[10:11], v[240:241] op_sel_hi:[1,0,0]
    v_pk_fma_f32 v[204:205], v[204:205], s[10:11], v[240:241] op_sel:[0,1,1] op_sel_hi:[1,1,1]
    v_pk_fma_f32 v[110:111], v[206:207], s[10:11], v[240:241] op_sel_hi:[1,0,0]
    v_pk_fma_f32 v[206:207], v[206:207], s[10:11], v[240:241] op_sel:[0,1,1] op_sel_hi:[1,1,1]
    v_pk_fma_f32 v[112:113], v[208:209], s[10:11], v[240:241] op_sel_hi:[1,0,0]
    v_pk_fma_f32 v[208:209], v[208:209], s[10:11], v[240:241] op_sel:[0,1,1] op_sel_hi:[1,1,1]
    v_pk_fma_f32 v[114:115], v[210:211], s[10:11], v[240:241] op_sel_hi:[1,0,0]
    v_pk_fma_f32 v[210:211], v[210:211], s[10:11], v[240:241] op_sel:[0,1,1] op_sel_hi:[1,1,1]
    v_pk_fma_f32 v[116:117], v[212:213], s[10:11], v[240:241] op_sel_hi:[1,0,0]
    v_pk_fma_f32 v[212:213], v[212:213], s[10:11], v[240:241] op_sel:[0,1,1] op_sel_hi:[1,1,1]
    v_pk_fma_f32 v[118:119], v[214:215], s[10:11], v[240:241] op_sel_hi:[1,0,0]
    v_pk_fma_f32 v[214:215], v[214:215], s[10:11], v[240:241] op_sel:[0,1,1] op_sel_hi:[1,1,1]
    v_pk_fma_f32 v[120:121], v[216:217], s[10:11], v[240:241] op_sel_hi:[1,0,0]
    v_pk_fma_f32 v[216:217], v[216:217], s[10:11], v[240:241] op_sel:[0,1,1] op_sel_hi:[1,1,1]
    v_pk_fma_f32 v[122:123], v[218:219], s[10:11], v[240:241] op_sel_hi:[1,0,0]
    v_pk_fma_f32 v[218:219], v[218:219], s[10:11], v[240:241] op_sel:[0,1,1] op_sel_hi:[1,1,1]
    v_exp_f32 v104, v104
    v_exp_f32 v200, v200
    v_exp_f32 v105, v105
    v_exp_f32 v201, v201
    v_exp_f32 v106, v106
    v_exp_f32 v202, v202
    v_exp_f32 v107, v107
    v_exp_f32 v203, v203
    v_exp_f32 v108, v108
    v_exp_f32 v204, v204
    v_exp_f32 v109, v109
    v_exp_f32 v205, v205
    v_exp_f32 v110, v110
    v_exp_f32 v206, v206
    v_exp_f32 v111, v111
    v_exp_f32 v207, v207
    v_exp_f32 v112, v112
    v_exp_f32 v208, v208
    v_exp_f32 v113, v113
    v_exp_f32 v209, v209
    v_exp_f32 v114, v114
    v_exp_f32 v210, v210
    v_exp_f32 v115, v115
    v_exp_f32 v211, v211
    v_exp_f32 v116, v116
    v_exp_f32 v212, v212
    v_exp_f32 v117, v117
    v_exp_f32 v213, v213
    v_exp_f32 v118, v118
    v_exp_f32 v214, v214
    v_exp_f32 v119, v119
    v_exp_f32 v215, v215
    v_exp_f32 v120, v120
    v_exp_f32 v216, v216
    v_exp_f32 v121, v121
    v_exp_f32 v217, v217
    v_exp_f32 v122, v122
    v_exp_f32 v218, v218
    v_exp_f32 v123, v123
    v_exp_f32 v219, v219
    v_pk_add_f32 v[242:243], v[104:105], v[106:107]
    v_pk_add_f32 v[244:245], v[200:201], v[202:203]
    v_pk_add_f32 v[242:243], v[242:243], v[108:109]
    v_pk_add_f32 v[244:245], v[244:245], v[204:205]
    v_pk_add_f32 v[242:243], v[242:243], v[110:111]
    v_pk_add_f32 v[244:245], v[244:245], v[206:207]
    v_pk_add_f32 v[242:243], v[242:243], v[112:113]
    v_pk_add_f32 v[244:245], v[244:245], v[208:209]
    v_pk_add_f32 v[242:243], v[242:243], v[114:115]
    v_pk_add_f32 v[244:245], v[244:245], v[210:211]
    v_pk_add_f32 v[242:243], v[242:243], v[116:117]
    v_pk_add_f32 v[244:245], v[244:245], v[212:213]
    v_pk_add_f32 v[242:243], v[242:243], v[118:119]
    v_pk_add_f32 v[244:245], v[244:245], v[214:215]
    v_pk_add_f32 v[242:243], v[242:243], v[120:121]
    v_pk_add_f32 v[244:245], v[244:245], v[216:217]
    v_pk_add_f32 v[242:243], v[242:243], v[122:123]
    v_pk_add_f32 v[244:245], v[244:245], v[218:219]
    v_add_f32 v242, v242, v243
    v_add_f32 v244, v244, v245
    v_rcp_f32 v242, v242
    v_rcp_f32 v244, v244
    v_pk_mul_f32 v[104:105], v[104:105], v[242:243] op_sel_hi:[1,0]
    v_pk_mul_f32 v[106:107], v[106:107], v[242:243] op_sel_hi:[1,0]
    v_pk_mul_f32 v[108:109], v[108:109], v[242:243] op_sel_hi:[1,0]
    v_pk_mul_f32 v[110:111], v[110:111], v[242:243] op_sel_hi:[1,0]
    v_pk_mul_f32 v[112:113], v[112:113], v[242:243] op_sel_hi:[1,0]
    v_pk_mul_f32 v[114:115], v[114:115], v[242:243] op_sel_hi:[1,0]
    v_pk_mul_f32 v[116:117], v[116:117], v[242:243] op_sel_hi:[1,0]
    v_cmp_ne_u64 vcc, s[70:71], v[24:25]
    s_cbranch_vccz L_pd1
    s_mov_b32 s95, 100000
L_pl1:
    buffer_load_dwordx2 v[24:25], v22, s[36:39], s91 offen sc1
    s_waitcnt vmcnt(0)
    v_cmp_ne_u64 vcc, s[70:71], v[24:25]
    s_cbranch_vccz L_pd1
    s_sub_u32 s95, s95, 1
    s_cbranch_scc0 L_pl1
L_pd1:
    s_add_u32 s23, s22, 0
    s_add_u32 m0, s23, 0
    s_add_u32 s23, s23, s21
    s_add_u32 s60, s36, s23
    s_addc_u32 s61, s37, 0
    global_load_lds_dwordx4 v1, s[60:61] offset:0 sc1
    v_pk_mul_f32 v[118:119], v[118:119], v[242:243] op_sel_hi:[1,0]
    v_pk_mul_f32 v[120:121], v[120:121], v[242:243] op_sel_hi:[1,0]
    v_pk_mul_f32 v[122:123], v[122:123], v[242:243] op_sel_hi:[1,0]
    v_cvt_pk_bf16_f32 v64, v104, v105
    v_cvt_pk_bf16_f32 v65, v106, v107
    v_cvt_pk_bf16_f32 v66, v108, v109
    v_cvt_pk_bf16_f32 v67, v110, v111
    ds_write_b128 v250, v[64:67] offset:0
    v_cvt_pk_bf16_f32 v68, v112, v113
    global_load_lds_dwordx4 v1, s[60:61] offset:1024 sc1
    v_cvt_pk_bf16_f32 v69, v114, v115
    v_cvt_pk_bf16_f32 v70, v116, v117
    v_cvt_pk_bf16_f32 v71, v118, v119
    v_cvt_pk_bf16_f32 v72, v120, v121
    v_cvt_pk_bf16_f32 v73, v122, v123
    v_pk_mul_f32 v[200:201], v[200:201], v[244:245] op_sel_hi:[1,0]
    v_pk_mul_f32 v[202:203], v[202:203], v[244:245] op_sel_hi:[1,0]
    v_pk_mul_f32 v[204:205], v[204:205], v[244:245] op_sel_hi:[1,0]
    v_pk_mul_f32 v[206:207], v[206:207], v[244:245] op_sel_hi:[1,0]
    ds_write_b128 v250, v[68:71] offset:16
    global_load_lds_dwordx4 v1, s[60:61] offset:2048 sc1
    v_pk_mul_f32 v[208:209], v[208:209], v[244:245] op_sel_hi:[1,0]
    v_pk_mul_f32 v[210:211], v[210:211], v[244:245] op_sel_hi:[1,0]
    v_pk_mul_f32 v[212:213], v[212:213], v[244:245] op_sel_hi:[1,0]
    v_pk_mul_f32 v[214:215], v[214:215], v[244:245] op_sel_hi:[1,0]
    v_pk_mul_f32 v[216:217], v[216:217], v[244:245] op_sel_hi:[1,0]
    v_pk_mul_f32 v[218:219], v[218:219], v[244:245] op_sel_hi:[1,0]
    v_cvt_pk_bf16_f32 v74, v200, v201
    v_cvt_pk_bf16_f32 v75, v202, v203
    v_cvt_pk_bf16_f32 v76, v204, v205
    ds_write_b128 v250, v[72:75] offset:32
    global_load_lds_dwordx4 v1, s[60:61] offset:3072 sc1
    v_cvt_pk_bf16_f32 v77, v206, v207
    v_cvt_pk_bf16_f32 v78, v208, v209
    v_cvt_pk_bf16_f32 v79, v210, v211
    v_cvt_pk_bf16_f32 v80, v212, v213
    v_cvt_pk_bf16_f32 v81, v214, v215
    v_cvt_pk_bf16_f32 v82, v216, v217
    v_cvt_pk_bf16_f32 v83, v218, v219
    ds_write_b128 v250, v[76:79] offset:48
    ds_write_b128 v250, v[80:83] offset:64
    s_waitcnt lgkmcnt(0)
    s_barrier
    ds_read_b64_tr_b16 v[152:153], v252 offset:0
    ds_read_b64_tr_b16 v[154:155], v252 offset:4608
    ds_read_b64_tr_b16 v[104:105], v251 offset:0
    ds_read_b64_tr_b16 v[106:107], v251 offset:4608
    ds_read_b64_tr_b16 v[108:109], v251 offset:32
    ds_read_b64_tr_b16 v[110:111], v251 offset:4640
    ds_read_b64_tr_b16 v[112:113], v251 offset:64
    ds_read_b64_tr_b16 v[114:115], v251 offset:4672
    ds_read_b64_tr_b16 v[156:157], v252 offset:9216
    ds_read_b64_tr_b16 v[158:159], v252 offset:13824
    ds_read_b64_tr_b16 v[116:117], v251 offset:9216
    ds_read_b64_tr_b16 v[118:119], v251 offset:13824
    ds_read_b64_tr_b16 v[120:121], v251 offset:9248
    ds_read_b64_tr_b16 v[122:123], v251 offset:13856
    ds_read_b64_tr_b16 v[124:125], v251 offset:9280
    ds_read_b64_tr_b16 v[126:127], v251 offset:13888
    s_lshl_b32 s72, s65, 4
    s_add_u32 s72, s72, s64
    s_mul_i32 s72, s72, 3584
    s_add_u32 s72, s72, 524288
    s_waitcnt lgkmcnt(12)
    v_mfma_f32_16x16x32_bf16 v[188:191], v[104:107], v[152:155], 0
    ds_read_b64_tr_b16 v[160:161], v252 offset:18432
    ds_read_b64_tr_b16 v[162:163], v252 offset:23040
    ds_read_b64_tr_b16 v[128:129], v251 offset:18432
    s_waitcnt lgkmcnt(13)
    v_mfma_f32_16x16x32_bf16 v[192:195], v[108:111], v[152:155], 0
    ds_read_b64_tr_b16 v[130:131], v251 offset:23040
    ds_read_b64_tr_b16 v[132:133], v251 offset:18464
    ds_read_b64_tr_b16 v[134:135], v251 offset:23072
    s_waitcnt lgkmcnt(14)
    v_mfma_f32_16x16x32_bf16 v[196:199], v[112:115], v[152:155], 0
    ds_read_b64_tr_b16 v[136:137], v251 offset:18496
    ds_read_b64_tr_b16 v[138:139], v251 offset:23104
    s_waitcnt lgkmcnt(12)
    v_mfma_f32_16x16x32_bf16 v[188:191], v[116:119], v[156:159], v[188:191]
    ds_read_b64_tr_b16 v[164:165], v252 offset:27648
    ds_read_b64_tr_b16 v[166:167], v252 offset:32256
    ds_read_b64_tr_b16 v[140:141], v251 offset:27648
    s_waitcnt lgkmcnt(13)
    v_mfma_f32_16x16x32_bf16 v[192:195], v[120:123], v[156:159], v[192:195]
    ds_read_b64_tr_b16 v[142:143], v251 offset:32256
    ds_read_b64_tr_b16 v[144:145], v251 offset:27680
    ds_read_b64_tr_b16 v[146:147], v251 offset:32288
    s_waitcnt lgkmcnt(14)
    v_mfma_f32_16x16x32_bf16 v[196:199], v[124:127], v[156:159], v[196:199]
    ds_read_b64_tr_b16 v[148:149], v251 offset:27712
    ds_read_b64_tr_b16 v[150:151], v251 offset:32320
    s_waitcnt lgkmcnt(12)
    v_mfma_f32_16x16x32_bf16 v[188:191], v[128:131], v[160:163], v[188:191]
    s_waitcnt lgkmcnt(10)
    v_mfma_f32_16x16x32_bf16 v[192:195], v[132:135], v[160:163], v[192:195]
    s_waitcnt lgkmcnt(8)
    v_mfma_f32_16x16x32_bf16 v[196:199], v[136:139], v[160:163], v[196:199]
    s_waitcnt lgkmcnt(4)
    v_mfma_f32_16x16x32_bf16 v[188:191], v[140:143], v[164:167], v[188:191]
    s_waitcnt lgkmcnt(2)
    v_mfma_f32_16x16x32_bf16 v[192:195], v[144:147], v[164:167], v[192:195]
    s_waitcnt lgkmcnt(0)
    v_mfma_f32_16x16x32_bf16 v[196:199], v[148:151], v[164:167], v[196:199]
    s_nop 3
    v_cvt_pk_bf16_f32 v200, v188, v189
    v_cvt_pk_bf16_f32 v201, v190, v191
    v_cvt_pk_bf16_f32 v202, v192, v193
    v_cvt_pk_bf16_f32 v203, v194, v195
    v_cvt_pk_bf16_f32 v204, v196, v197
    v_cvt_pk_bf16_f32 v205, v198, v199
    buffer_store_dwordx4 v[200:203], v254, s[36:39], s72 offen sc1
    buffer_store_dwordx2 v[204:205], v255, s[36:39], s72 offen sc1
    ds_read_b128 v[64:67], v39 offset:0
    ds_read_b128 v[68:71], v39 offset:1024
    ds_read_b128 v[72:75], v39 offset:2048
    v_mfma_f32_16x16x32_bf16 v[112:115], a[240:243], v[60:63], 0
    v_mfma_f32_16x16x32_bf16 v[124:127], a[244:247], v[60:63], 0
    s_add_u32 s20, s3, 4
    v_mfma_f32_16x16x32_bf16 v[136:139], a[248:251], v[60:63], 0
    s_sub_u32 s79, s20, 5
    s_cselect_b32 s20, s20, s79
    s_mul_i32 s20, s20, 12288
    s_add_u32 s20, s20, s19
    s_add_u32 s34, s36, s20
    s_addc_u32 s35, s37, 0
    s_add_u32 m0, s88, 151552
    s_nop 0
    global_load_lds_dwordx4 v1, s[34:35] offset:0 sc1
    s_waitcnt lgkmcnt(2)
    v_mfma_f32_16x16x32_bf16 v[104:107], v[64:67], a[0:3], 0
    ds_read_b128 v[76:79], v39 offset:3072
    v_mfma_f32_16x16x32_bf16 v[108:111], v[64:67], a[16:19], 0
    s_waitcnt lgkmcnt(2)
    v_mfma_f32_16x16x32_bf16 v[116:119], v[68:71], a[0:3], 0
    ds_read_b128 v[80:83], v39 offset:4096
    v_mfma_f32_16x16x32_bf16 v[120:123], v[68:71], a[16:19], 0
    s_waitcnt lgkmcnt(2)
    v_mfma_f32_16x16x32_bf16 v[128:131], v[72:75], a[0:3], 0
    ds_read_b128 v[84:87], v39 offset:5120
    global_load_lds_dwordx4 v1, s[34:35] offset:1024 sc1
    v_mfma_f32_16x16x32_bf16 v[132:135], v[72:75], a[16:19], 0
    s_waitcnt lgkmcnt(2)
    v_mfma_f32_16x16x32_bf16 v[104:107], v[76:79], a[4:7], v[104:107]
    ds_read_b128 v[64:67], v39 offset:6144
    v_mfma_f32_16x16x32_bf16 v[108:111], v[76:79], a[20:23], v[108:111]
    s_waitcnt lgkmcnt(2)
    v_mfma_f32_16x16x32_bf16 v[116:119], v[80:83], a[4:7], v[116:119]
    ds_read_b128 v[68:71], v39 offset:7168
    v_mfma_f32_16x16x32_bf16 v[120:123], v[80:83], a[20:23], v[120:123]
    global_load_lds_dwordx4 v1, s[34:35] offset:2048 sc1
    s_waitcnt lgkmcnt(2)
    v_mfma_f32_16x16x32_bf16 v[128:131], v[84:87], a[4:7], v[128:131]
    ds_read_b128 v[72:75], v39 offset:8192
    v_mfma_f32_16x16x32_bf16 v[132:135], v[84:87], a[20:23], v[132:135]
    s_waitcnt lgkmcnt(2)
    v_mfma_f32_16x16x32_bf16 v[104:107], v[64:67], a[8:11], v[104:107]
    ds_read_b128 v[76:79], v39 offset:9216
    v_mfma_f32_16x16x32_bf16 v[108:111], v[64:67], a[24:27], v[108:111]
    s_add_u32 s23, s22, 16384
    s_add_u32 m0, s23, 0
    s_waitcnt lgkmcnt(2)
    v_mfma_f32_16x16x32_bf16 v[116:119], v[68:71], a[8:11], v[116:119]
    ds_read_b128 v[80:83], v39 offset:10240
    s_add_u32 s23, s23, s21
    v_mfma_f32_16x16x32_bf16 v[120:123], v[68:71], a[24:27], v[120:123]
    s_add_u32 s60, s36, s23
    s_addc_u32 s61, s37, 0
    global_load_lds_dwordx4 v1, s[60:61] offset:0 sc1
    s_waitcnt lgkmcnt(2)
    v_mfma_f32_16x16x32_bf16 v[128:131], v[72:75], a[8:11], v[128:131]
    ds_read_b128 v[84:87], v39 offset:11264
    v_mfma_f32_16x16x32_bf16 v[132:135], v[72:75], a[24:27], v[132:135]
    s_waitcnt lgkmcnt(2)
    v_mfma_f32_16x16x32_bf16 v[104:107], v[76:79], a[12:15], v[104:107]
    ds_read_b128 v[64:67], v39 offset:12288
    v_mfma_f32_16x16x32_bf16 v[108:111], v[76:79], a[28:31], v[108:111]
    s_waitcnt lgkmcnt(2)
    v_mfma_f32_16x16x32_bf16 v[116:119], v[80:83], a[12:15], v[116:119]
    ds_read_b128 v[68:71], v39 offset:13312
    global_load_lds_dwordx4 v1, s[60:61] offset:1024 sc1
    v_mfma_f32_16x16x32_bf16 v[120:123], v[80:83], a[28:31], v[120:123]
    s_waitcnt lgkmcnt(2)
    v_mfma_f32_16x16x32_bf16 v[128:131], v[84:87], a[12:15], v[128:131]
    ds_read_b128 v[72:75], v39 offset:14336
    v_mfma_f32_16x16x32_bf16 v[132:135], v[84:87], a[28:31], v[132:135]
    s_waitcnt lgkmcnt(2)
    v_mfma_f32_16x16x32_bf16 v[104:107], v[64:67], a[32:35], v[104:107]
    ds_read_b128 v[76:79], v39 offset:15360
    global_load_lds_dwordx4 v1, s[60:61] offset:2048 sc1
    v_mfma_f32_16x16x32_bf16 v[108:111], v[64:67], a[48:51], v[108:111]
    s_waitcnt lgkmcnt(2)
    v_mfma_f32_16x16x32_bf16 v[116:119], v[68:71], a[32:35], v[116:119]
    ds_read_b128 v[80:83], v39 offset:16384
    v_mfma_f32_16x16x32_bf16 v[120:123], v[68:71], a[48:51], v[120:123]
    s_waitcnt lgkmcnt(2)
    v_mfma_f32_16x16x32_bf16 v[128:131], v[72:75], a[32:35], v[128:131]
    ds_read_b128 v[84:87], v39 offset:17408
    v_mfma_f32_16x16x32_bf16 v[132:135], v[72:75], a[48:51], v[132:135]
    global_load_lds_dwordx4 v1, s[60:61] offset:3072 sc1
    s_waitcnt lgkmcnt(2)
    v_mfma_f32_16x16x32_bf16 v[104:107], v[76:79], a[36:39], v[104:107]
    ds_read_b128 v[64:67], v39 offset:18432
    v_mfma_f32_16x16x32_bf16 v[108:111], v[76:79], a[52:55], v[108:111]
    s_waitcnt lgkmcnt(2)
    v_mfma_f32_16x16x32_bf16 v[116:119], v[80:83], a[36:39], v[116:119]
    ds_read_b128 v[68:71], v39 offset:19456
    v_mfma_f32_16x16x32_bf16 v[120:123], v[80:83], a[52:55], v[120:123]
    s_waitcnt vmcnt(7)
    s_barrier
    s_lshl_b32 s72, s64, 11
    s_lshl_b32 s73, s65, 7
    s_add_u32 s72, s72, s73
    s_add_u32 s72, s72, 36864
    buffer_store_dwordx2 v[8:9], v5, s[36:39], s72 offen sc1
    s_waitcnt lgkmcnt(2)
    v_mfma_f32_16x16x32_bf16 v[128:131], v[84:87], a[36:39], v[128:131]
    ds_read_b128 v[72:75], v39 offset:20480
    v_mfma_f32_16x16x32_bf16 v[132:135], v[84:87], a[52:55], v[132:135]
    ds_read_b64_tr_b16 v[188:189], v220 offset:0
    ds_read_b64_tr_b16 v[190:191], v220 offset:768
    s_waitcnt lgkmcnt(4)
    v_mfma_f32_16x16x32_bf16 v[104:107], v[64:67], a[40:43], v[104:107]
    ds_read_b128 v[76:79], v39 offset:21504
    ds_read_b64_tr_b16 v[192:193], v220 offset:16
    v_mfma_f32_16x16x32_bf16 v[108:111], v[64:67], a[56:59], v[108:111]
    ds_read_b64_tr_b16 v[194:195], v220 offset:784
    ds_read_b64_tr_b16 v[196:197], v220 offset:32
    s_waitcnt lgkmcnt(7)
    v_mfma_f32_16x16x32_bf16 v[116:119], v[68:71], a[40:43], v[116:119]
    ds_read_b128 v[80:83], v39 offset:22528
    ds_read_b64_tr_b16 v[198:199], v220 offset:800
    v_mfma_f32_16x16x32_bf16 v[120:123], v[68:71], a[56:59], v[120:123]
    ds_read_b64_tr_b16 v[200:201], v221 offset:3072
    ds_read_b64_tr_b16 v[202:203], v221 offset:6912
    s_waitcnt lgkmcnt(10)
    v_mfma_f32_16x16x32_bf16 v[128:131], v[72:75], a[40:43], v[128:131]
    ds_read_b128 v[84:87], v39 offset:23552
    ds_read_b64_tr_b16 v[208:209], v224
    v_mfma_f32_16x16x32_bf16 v[132:135], v[72:75], a[56:59], v[132:135]
    ds_read_b64_tr_b16 v[210:211], v225
    ds_read_b64_tr_b16 v[212:213], v227
    s_waitcnt lgkmcnt(11)
    v_mfma_f32_16x16x32_bf16 v[104:107], v[76:79], a[44:47], v[104:107]
    ds_read_b128 v[64:67], v39 offset:24576
    ds_read_b64_tr_b16 v[214:215], v228
    v_mfma_f32_16x16x32_bf16 v[108:111], v[76:79], a[60:63], v[108:111]
    s_waitcnt lgkmcnt(9)
    v_mfma_f32_16x16x32_bf16 v[116:119], v[80:83], a[44:47], v[116:119]
    ds_read_b128 v[68:71], v39 offset:25600
    s_mul_i32 s99, s65, 245760
    v_mfma_f32_16x16x32_bf16 v[120:123], v[80:83], a[60:63], v[120:123]
    s_mul_i32 s100, s67, 61440
    s_add_u32 s99, s99, s100
    s_waitcnt lgkmcnt(6)
    v_mfma_f32_16x16x32_bf16 v[128:131], v[84:87], a[44:47], v[128:131]
    ds_read_b128 v[72:75], v39 offset:26624
    s_mul_i32 s100, s64, 1280
    s_add_u32 s99, s99, s100
    s_add_u32 s99, s99, 17825792
    buffer_store_dwordx4 v[200:203], v223, s[36:39], s99 offen offset:1024 sc1
    v_mfma_f32_16x16x32_bf16 v[132:135], v[84:87], a[60:63], v[132:135]
    buffer_store_dwordx4 v[188:191], v222, s[36:39], s99 offen sc1
    s_waitcnt lgkmcnt(3)
    v_mfma_f32_16x16x32_bf16 v[104:107], v[64:67], a[64:67], v[104:107]
    ds_read_b128 v[76:79], v39 offset:27648
    s_add_u32 s99, s99, 20480
    v_mfma_f32_16x16x32_bf16 v[108:111], v[64:67], a[80:83], v[108:111]
    buffer_store_dwordx4 v[192:195], v222, s[36:39], s99 offen sc1
    s_waitcnt lgkmcnt(2)
    v_mfma_f32_16x16x32_bf16 v[116:119], v[68:71], a[64:67], v[116:119]
    ds_read_b128 v[80:83], v39 offset:28672
    s_add_u32 s99, s99, 20480
    v_mfma_f32_16x16x32_bf16 v[120:123], v[68:71], a[80:83], v[120:123]
    buffer_store_dwordx4 v[196:199], v222, s[36:39], s99 offen sc1
    s_waitcnt lgkmcnt(2)
    v_mfma_f32_16x16x32_bf16 v[128:131], v[72:75], a[64:67], v[128:131]
    ds_read_b128 v[84:87], v39 offset:29696
    v_mfma_f32_16x16x32_bf16 v[132:135], v[72:75], a[80:83], v[132:135]
    s_mul_i32 s100, s68, 245760
    s_waitcnt lgkmcnt(2)
    v_mfma_f32_16x16x32_bf16 v[104:107], v[76:79], a[68:71], v[104:107]
    ds_read_b128 v[64:67], v39 offset:30720
    s_add_u32 s100, s100, 22020096
    v_mfma_f32_16x16x32_bf16 v[108:111], v[76:79], a[84:87], v[108:111]
    buffer_store_dwordx4 v[208:211], v226, s[36:39], s100 offen sc1
    s_waitcnt lgkmcnt(2)
    v_mfma_f32_16x16x32_bf16 v[116:119], v[80:83], a[68:71], v[116:119]
    ds_read_b128 v[68:71], v39 offset:31744
    v_mfma_f32_16x16x32_bf16 v[120:123], v[80:83], a[84:87], v[120:123]
    buffer_store_dwordx4 v[212:215], v229, s[36:39], s100 offen sc1
    s_waitcnt lgkmcnt(2)
    v_mfma_f32_16x16x32_bf16 v[128:131], v[84:87], a[68:71], v[128:131]
    ds_read_b128 v[72:75], v39 offset:32768
    v_mfma_f32_16x16x32_bf16 v[132:135], v[84:87], a[84:87], v[132:135]
    s_waitcnt lgkmcnt(2)
    v_cmp_eq_u32 s[76:77], 0, v14
    v_mfma_f32_16x16x32_bf16 v[104:107], v[64:67], a[72:75], v[104:107]
    ds_read_b128 v[76:79], v39 offset:33792
    v_cndmask_b32 v216, 0, v60, s[76:77]
    v_mfma_f32_16x16x32_bf16 v[108:111], v[64:67], a[88:91], v[108:111]
    s_waitcnt lgkmcnt(2)
    v_cndmask_b32 v217, 0, v60, s[76:77]
    v_cndmask_b32 v218, 0, v60, s[76:77]
    v_mfma_f32_16x16x32_bf16 v[116:119], v[68:71], a[72:75], v[116:119]
    ds_read_b128 v[80:83], v39 offset:34816
    v_cndmask_b32 v219, 0, v60, s[76:77]
    v_mfma_f32_16x16x32_bf16 v[120:123], v[68:71], a[88:91], v[120:123]
    s_nop 0
    v_mfma_f32_16x16x32_bf16 v[236:239], v[216:219], v[188:191], 0
    s_waitcnt lgkmcnt(2)
    v_mfma_f32_16x16x32_bf16 v[128:131], v[72:75], a[72:75], v[128:131]
    ds_read_b128 v[84:87], v39 offset:35840
    v_cmp_eq_u32 s[76:77], 1, v14
    v_mfma_f32_16x16x32_bf16 v[132:135], v[72:75], a[88:91], v[132:135]
    s_waitcnt lgkmcnt(2)
    v_cndmask_b32 v216, 0, v60, s[76:77]
    v_cndmask_b32 v217, 0, v60, s[76:77]
    v_mfma_f32_16x16x32_bf16 v[104:107], v[76:79], a[76:79], v[104:107]
    ds_read_b128 v[64:67], v39 offset:36864
    v_cndmask_b32 v218, 0, v60, s[76:77]
    v_mfma_f32_16x16x32_bf16 v[108:111], v[76:79], a[92:95], v[108:111]
    s_add_u32 s23, s22, 65536
    s_add_u32 m0, s23, 0
    s_waitcnt lgkmcnt(2)
    v_mfma_f32_16x16x32_bf16 v[116:119], v[80:83], a[76:79], v[116:119]
    ds_read_b128 v[68:71], v39 offset:37888
    s_add_u32 s23, s23, s21
    v_mfma_f32_16x16x32_bf16 v[120:123], v[80:83], a[92:95], v[120:123]
    s_add_u32 s60, s36, s23
    s_addc_u32 s61, s37, 0
    s_waitcnt lgkmcnt(2)
    v_mfma_f32_16x16x32_bf16 v[128:131], v[84:87], a[76:79], v[128:131]
    ds_read_b128 v[72:75], v39 offset:38912
    global_load_lds_dwordx4 v1, s[60:61] offset:0 sc1
    v_cndmask_b32 v219, 0, v60, s[76:77]
    v_mfma_f32_16x16x32_bf16 v[132:135], v[84:87], a[92:95], v[132:135]
    s_nop 0
    v_mfma_f32_16x16x32_bf16 v[236:239], v[216:219], v[192:195], v[236:239]
    s_waitcnt lgkmcnt(2)
    v_mfma_f32_16x16x32_bf16 v[104:107], v[64:67], a[96:99], v[104:107]
    ds_read_b128 v[76:79], v39 offset:39936
    v_cmp_eq_u32 s[76:77], 2, v14
    v_mfma_f32_16x16x32_bf16 v[108:111], v[64:67], a[112:115], v[108:111]
    global_load_lds_dwordx4 v1, s[60:61] offset:1024 sc1
    v_cndmask_b32 v216, 0, v60, s[76:77]
    s_waitcnt lgkmcnt(2)
    v_mfma_f32_16x16x32_bf16 v[116:119], v[68:71], a[96:99], v[116:119]
    ds_read_b128 v[80:83], v39 offset:40960
    global_load_lds_dwordx4 v1, s[60:61] offset:2048 sc1
    v_mfma_f32_16x16x32_bf16 v[120:123], v[68:71], a[112:115], v[120:123]
    s_waitcnt lgkmcnt(2)
    v_cndmask_b32 v217, 0, v60, s[76:77]
    v_cndmask_b32 v218, 0, v60, s[76:77]
    v_mfma_f32_16x16x32_bf16 v[128:131], v[72:75], a[96:99], v[128:131]
    ds_read_b128 v[84:87], v39 offset:41984
    v_cndmask_b32 v219, 0, v60, s[76:77]
    v_mfma_f32_16x16x32_bf16 v[132:135], v[72:75], a[112:115], v[132:135]
    s_nop 0
    v_mfma_f32_16x16x32_bf16 v[236:239], v[216:219], v[196:199], v[236:239]
    s_waitcnt lgkmcnt(2)
    v_cmp_eq_u32 s[76:77], v2, v14
    v_mfma_f32_16x16x32_bf16 v[104:107], v[76:79], a[100:103], v[104:107]
    ds_read_b128 v[64:67], v39 offset:43008
    v_cndmask_b32 v216, 0, v60, s[76:77]
    v_mfma_f32_16x16x32_bf16 v[108:111], v[76:79], a[116:119], v[108:111]
    s_waitcnt lgkmcnt(2)
    v_cndmask_b32 v217, 0, v60, s[76:77]
    v_cndmask_b32 v218, 0, v60, s[76:77]
    v_cndmask_b32 v219, 0, v60, s[76:77]
    v_mfma_f32_16x16x32_bf16 v[116:119], v[80:83], a[100:103], v[116:119]
    ds_read_b128 v[68:71], v39 offset:44032
    v_mfma_f32_16x16x32_bf16 v[236:239], v[216:219], v[200:203], v[236:239]
    v_lshlrev_b32 v11, 8, v2
    v_mul_u32_u24 v11, 3, v11
    v_add_u32 v11, v11, v222
    v_mov_b32 v12, 1073741824
    v_cmp_gt_u32 s[76:77], 3, v2
    s_mul_i32 s99, s65, 12288
    s_mul_i32 s100, s67, 3072
    s_add_u32 s99, s99, s100
    v_cndmask_b32 v11, v12, v11, s[76:77]
    s_lshr_b32 s100, s64, 2
    s_lshl_b32 s100, s100, 8
    s_add_u32 s99, s99, s100
    v_cvt_pk_bf16_f32 v237, v236, v236
    s_and_b32 s100, s64, 3
    s_lshl_b32 s100, s100, 2
    s_add_u32 s99, s99, s100
    v_lshlrev_b32 v237, 16, v237
    v_sub_f32 v237, v236, v237
    v_cvt_pk_bf16_f32 v237, v236, v237
    s_add_u32 s99, s99, 29360128
    buffer_store_dword v237, v11, s[36:39], s99 offen sc1
    v_mfma_f32_16x16x32_bf16 v[120:123], v[80:83], a[116:119], v[120:123]
    s_waitcnt lgkmcnt(2)
    v_mfma_f32_16x16x32_bf16 v[128:131], v[84:87], a[100:103], v[128:131]
    ds_read_b128 v[72:75], v39 offset:45056
    v_mfma_f32_16x16x32_bf16 v[132:135], v[84:87], a[116:119], v[132:135]
    s_waitcnt lgkmcnt(2)
    v_mfma_f32_16x16x32_bf16 v[104:107], v[64:67], a[104:107], v[104:107]
    ds_read_b128 v[76:79], v39 offset:46080
    v_mfma_f32_16x16x32_bf16 v[108:111], v[64:67], a[120:123], v[108:111]
    global_load_lds_dwordx4 v1, s[60:61] offset:3072 sc1
    s_waitcnt lgkmcnt(2)
    v_mfma_f32_16x16x32_bf16 v[116:119], v[68:71], a[104:107], v[116:119]
    ds_read_b128 v[80:83], v39 offset:47104
    s_add_u32 s23, s22, 81920
    v_mfma_f32_16x16x32_bf16 v[120:123], v[68:71], a[120:123], v[120:123]
    s_add_u32 m0, s23, 0
    s_add_u32 s23, s23, s21
    s_waitcnt lgkmcnt(2)
    v_mfma_f32_16x16x32_bf16 v[128:131], v[72:75], a[104:107], v[128:131]
    ds_read_b128 v[84:87], v39 offset:48128
    s_waitcnt vmcnt(16)
    s_barrier
    v_mfma_f32_16x16x32_bf16 v[132:135], v[72:75], a[120:123], v[132:135]
    s_add_u32 s60, s36, s23
    s_addc_u32 s61, s37, 0
    s_waitcnt lgkmcnt(2)
    v_mfma_f32_16x16x32_bf16 v[104:107], v[76:79], a[108:111], v[104:107]
    ds_read_b128 v[64:67], v39 offset:49152
    v_mfma_f32_16x16x32_bf16 v[108:111], v[76:79], a[124:127], v[108:111]
    global_load_lds_dwordx4 v1, s[60:61] offset:0 sc1
    s_waitcnt lgkmcnt(2)
    v_mfma_f32_16x16x32_bf16 v[116:119], v[80:83], a[108:111], v[116:119]
    ds_read_b128 v[68:71], v39 offset:50176
    v_mfma_f32_16x16x32_bf16 v[120:123], v[80:83], a[124:127], v[120:123]
    s_waitcnt lgkmcnt(2)
    v_mfma_f32_16x16x32_bf16 v[128:131], v[84:87], a[108:111], v[128:131]
    ds_read_b128 v[72:75], v39 offset:51200
    v_mfma_f32_16x16x32_bf16 v[132:135], v[84:87], a[124:127], v[132:135]
    s_waitcnt lgkmcnt(2)
    v_mfma_f32_16x16x32_bf16 v[104:107], v[64:67], a[128:131], v[104:107]
    ds_read_b128 v[76:79], v39 offset:52224
    global_load_lds_dwordx4 v1, s[60:61] offset:1024 sc1
    v_mfma_f32_16x16x32_bf16 v[108:111], v[64:67], a[144:147], v[108:111]
    s_waitcnt lgkmcnt(2)
    v_mfma_f32_16x16x32_bf16 v[116:119], v[68:71], a[128:131], v[116:119]
    ds_read_b128 v[80:83], v39 offset:53248
    v_mfma_f32_16x16x32_bf16 v[120:123], v[68:71], a[144:147], v[120:123]
    s_waitcnt lgkmcnt(2)
    v_mfma_f32_16x16x32_bf16 v[128:131], v[72:75], a[128:131], v[128:131]
    ds_read_b128 v[84:87], v39 offset:54272
    v_mfma_f32_16x16x32_bf16 v[132:135], v[72:75], a[144:147], v[132:135]
    global_load_lds_dwordx4 v1, s[60:61] offset:2048 sc1
    s_waitcnt lgkmcnt(2)
    v_mfma_f32_16x16x32_bf16 v[104:107], v[76:79], a[132:135], v[104:107]
    ds_read_b128 v[64:67], v39 offset:55296
    v_mfma_f32_16x16x32_bf16 v[108:111], v[76:79], a[148:151], v[108:111]
    s_waitcnt lgkmcnt(2)
    v_mfma_f32_16x16x32_bf16 v[116:119], v[80:83], a[132:135], v[116:119]
    ds_read_b128 v[68:71], v39 offset:56320
    v_mfma_f32_16x16x32_bf16 v[120:123], v[80:83], a[148:151], v[120:123]
    s_waitcnt lgkmcnt(2)
    v_mfma_f32_16x16x32_bf16 v[128:131], v[84:87], a[132:135], v[128:131]
    ds_read_b128 v[72:75], v39 offset:57344
    global_load_lds_dwordx4 v1, s[60:61] offset:3072 sc1
    v_mfma_f32_16x16x32_bf16 v[132:135], v[84:87], a[148:151], v[132:135]
    s_waitcnt lgkmcnt(2)
    v_mov_b32 v52, 0
    v_mov_b32 v53, 0
    v_mfma_f32_16x16x32_bf16 v[104:107], v[64:67], a[136:139], v[104:107]
    ds_read_b128 v[76:79], v39 offset:58368
    s_lshl_b32 s23, s67, 10
    v_mfma_f32_16x16x32_bf16 v[108:111], v[64:67], a[152:155], v[108:111]
    s_add_u32 s23, s23, 98304
    s_add_u32 m0, s23, 0
    s_waitcnt lgkmcnt(2)
    v_mfma_f32_16x16x32_bf16 v[116:119], v[68:71], a[136:139], v[116:119]
    ds_read_b128 v[80:83], v39 offset:59392
    s_add_u32 s23, s23, s21
    v_mfma_f32_16x16x32_bf16 v[120:123], v[68:71], a[152:155], v[120:123]
    s_add_u32 s60, s36, s23
    s_addc_u32 s61, s37, 0
    s_waitcnt lgkmcnt(2)
    v_mfma_f32_16x16x32_bf16 v[128:131], v[72:75], a[136:139], v[128:131]
    ds_read_b128 v[84:87], v39 offset:60416
    global_load_lds_dwordx4 v1, s[60:61] offset:0 sc1
    v_mfma_f32_16x16x32_bf16 v[132:135], v[72:75], a[152:155], v[132:135]
    ds_write_b64 v31, v[52:53] offset:4224
    s_waitcnt lgkmcnt(3)
    v_mfma_f32_16x16x32_bf16 v[104:107], v[76:79], a[140:143], v[104:107]
    s_add_u32 s23, s22, 32768
    s_add_u32 m0, s23, 0
    v_mfma_f32_16x16x32_bf16 v[108:111], v[76:79], a[156:159], v[108:111]
    ds_write_b64 v31, v[52:53] offset:4232
    s_waitcnt lgkmcnt(3)
    v_mfma_f32_16x16x32_bf16 v[116:119], v[80:83], a[140:143], v[116:119]
    s_add_u32 s23, s23, s21
    s_add_u32 s60, s36, s23
    s_addc_u32 s61, s37, 0
    v_mfma_f32_16x16x32_bf16 v[120:123], v[80:83], a[156:159], v[120:123]
    global_load_lds_dwordx4 v1, s[60:61] offset:0 sc1
    s_waitcnt lgkmcnt(2)
    v_mfma_f32_16x16x32_bf16 v[128:131], v[84:87], a[140:143], v[128:131]
    v_mfma_f32_16x16x32_bf16 v[132:135], v[84:87], a[156:159], v[132:135]
    v_pk_fma_f32 v[104:105], v[112:113], v[180:181], v[104:105] op_sel_hi:[1,0,1]
    v_pk_fma_f32 v[106:107], v[114:115], v[180:181], v[106:107] op_sel_hi:[1,0,1]
    v_pk_mul_f32 v[104:105], v[104:105], v[180:181] op_sel:[0,1] op_sel_hi:[1,1]
    v_pk_mul_f32 v[106:107], v[106:107], v[180:181] op_sel:[0,1] op_sel_hi:[1,1]
    v_cvt_pk_bf16_f32 v188, v104, v105
    v_cvt_pk_bf16_f32 v189, v106, v107
    v_pk_fma_f32 v[116:117], v[124:125], v[180:181], v[116:117] op_sel_hi:[1,0,1]
    v_pk_fma_f32 v[118:119], v[126:127], v[180:181], v[118:119] op_sel_hi:[1,0,1]
    v_pk_mul_f32 v[116:117], v[116:117], v[180:181] op_sel:[0,1] op_sel_hi:[1,1]
    v_pk_mul_f32 v[118:119], v[118:119], v[180:181] op_sel:[0,1] op_sel_hi:[1,1]
    v_cvt_pk_bf16_f32 v190, v116, v117
    v_cvt_pk_bf16_f32 v191, v118, v119
    v_pk_fma_f32 v[128:129], v[136:137], v[180:181], v[128:129] op_sel_hi:[1,0,1]
    v_pk_fma_f32 v[130:131], v[138:139], v[180:181], v[130:131] op_sel_hi:[1,0,1]
    v_pk_mul_f32 v[128:129], v[128:129], v[180:181] op_sel:[0,1] op_sel_hi:[1,1]
    v_pk_mul_f32 v[130:131], v[130:131], v[180:181] op_sel:[0,1] op_sel_hi:[1,1]
    v_cvt_pk_bf16_f32 v192, v128, v129
    v_cvt_pk_bf16_f32 v193, v130, v131
    v_pk_fma_f32 v[108:109], v[112:113], v[182:183], v[108:109] op_sel_hi:[1,0,1]
    v_pk_fma_f32 v[110:111], v[114:115], v[182:183], v[110:111] op_sel_hi:[1,0,1]
    v_pk_mul_f32 v[108:109], v[108:109], v[182:183] op_sel:[0,1] op_sel_hi:[1,1]
    v_pk_mul_f32 v[110:111], v[110:111], v[182:183] op_sel:[0,1] op_sel_hi:[1,1]
    v_cvt_pk_bf16_f32 v194, v108, v109
    v_cvt_pk_bf16_f32 v195, v110, v111
    v_pk_fma_f32 v[120:121], v[124:125], v[182:183], v[120:121] op_sel_hi:[1,0,1]
    v_pk_fma_f32 v[122:123], v[126:127], v[182:183], v[122:123] op_sel_hi:[1,0,1]
    v_pk_mul_f32 v[120:121], v[120:121], v[182:183] op_sel:[0,1] op_sel_hi:[1,1]
    v_pk_mul_f32 v[122:123], v[122:123], v[182:183] op_sel:[0,1] op_sel_hi:[1,1]
    v_cvt_pk_bf16_f32 v196, v120, v121
    v_cvt_pk_bf16_f32 v197, v122, v123
    v_pk_fma_f32 v[132:133], v[136:137], v[182:183], v[132:133] op_sel_hi:[1,0,1]
    buffer_load_dwordx2 v[20:21], v7, s[36:39], s27 offen sc1
    v_pk_fma_f32 v[134:135], v[138:139], v[182:183], v[134:135] op_sel_hi:[1,0,1]
    v_pk_mul_f32 v[132:133], v[132:133], v[182:183] op_sel:[0,1] op_sel_hi:[1,1]
    v_pk_mul_f32 v[134:135], v[134:135], v[182:183] op_sel:[0,1] op_sel_hi:[1,1]
    v_cvt_pk_bf16_f32 v198, v132, v133
    v_cvt_pk_bf16_f32 v199, v134, v135
    v_mfma_f32_16x16x32_bf16 v[200:203], a[160:163], v[188:191], 0
    v_mfma_f32_16x16x32_bf16 v[204:207], a[168:171], v[188:191], 0
    v_mfma_f32_16x16x32_bf16 v[208:211], a[176:179], v[188:191], 0
    v_mfma_f32_16x16x32_bf16 v[212:215], a[184:187], v[188:191], 0
    v_mfma_f32_16x16x32_bf16 v[216:219], a[192:195], v[188:191], 0
    v_mfma_f32_16x16x32_bf16 v[200:203], a[164:167], v[190:193], v[200:203]
    v_mfma_f32_16x16x32_bf16 v[204:207], a[172:175], v[190:193], v[204:207]
    v_mfma_f32_16x16x32_bf16 v[208:211], a[180:183], v[190:193], v[208:211]
    v_mfma_f32_16x16x32_bf16 v[212:215], a[188:191], v[190:193], v[212:215]
    v_mfma_f32_16x16x32_bf16 v[216:219], a[196:199], v[190:193], v[216:219]
    v_mfma_f32_16x16x32_bf16 v[200:203], a[200:203], v[194:197], v[200:203]
    v_mfma_f32_16x16x32_bf16 v[204:207], a[208:211], v[194:197], v[204:207]
    v_mfma_f32_16x16x32_bf16 v[208:211], a[216:219], v[194:197], v[208:211]
    v_mfma_f32_16x16x32_bf16 v[212:215], a[224:227], v[194:197], v[212:215]
    v_mfma_f32_16x16x32_bf16 v[216:219], a[232:235], v[194:197], v[216:219]
    v_mfma_f32_16x16x32_bf16 v[200:203], a[204:207], v[196:199], v[200:203]
    v_mfma_f32_16x16x32_bf16 v[204:207], a[212:215], v[196:199], v[204:207]
    v_mfma_f32_16x16x32_bf16 v[208:211], a[220:223], v[196:199], v[208:211]
    v_mfma_f32_16x16x32_bf16 v[212:215], a[228:231], v[196:199], v[212:215]
    v_mfma_f32_16x16x32_bf16 v[216:219], a[236:239], v[196:199], v[216:219]
    s_nop 3
    v_max3_f32 v240, v200, v201, v202
    v_min3_f32 v241, v200, v201, v202
    v_max3_f32 v240, v240, v203, v204
    v_min3_f32 v241, v241, v203, v204
    v_max3_f32 v240, v240, v205, v206
    v_min3_f32 v241, v241, v205, v206
    v_max3_f32 v240, v240, v207, v208
    v_min3_f32 v241, v241, v207, v208
    v_max3_f32 v240, v240, v209, v210
    v_min3_f32 v241, v241, v209, v210
    v_max3_f32 v240, v240, v211, v212
    v_min3_f32 v241, v241, v211, v212
    v_max3_f32 v240, v240, v213, v214
    v_min3_f32 v241, v241, v213, v214
    v_max3_f32 v240, v240, v215, v216
    v_min3_f32 v241, v241, v215, v216
    v_max3_f32 v240, v240, v217, v218
    v_min3_f32 v241, v241, v217, v218
    v_max_f32 v240, v240, v219
    v_min_f32 v241, v241, v219
    v_mul_f32 v240, s11, v240
    v_mul_f32 v241, s10, v241
    v_pk_fma_f32 v[104:105], v[200:201], s[10:11], v[240:241] op_sel_hi:[1,0,0]
    v_pk_fma_f32 v[200:201], v[200:201], s[10:11], v[240:241] op_sel:[0,1,1] op_sel_hi:[1,1,1]
    v_pk_fma_f32 v[106:107], v[202:203], s[10:11], v[240:241] op_sel_hi:[1,0,0]
    s_waitcnt vmcnt(8)
    s_barrier
    s_lshl_b32 s72, s64, 11
    s_lshl_b32 s73, s65, 7
    s_add_u32 s72, s72, s73
    s_add_u32 s72, s72, 4096
    buffer_store_dwordx2 v[8:9], v5, s[36:39], s72 offen sc1
    v_pk_fma_f32 v[202:203], v[202:203], s[10:11], v[240:241] op_sel:[0,1,1] op_sel_hi:[1,1,1]
    v_pk_fma_f32 v[108:109], v[204:205], s[10:11], v[240:241] op_sel_hi:[1,0,0]
    v_pk_fma_f32 v[204:205], v[204:205], s[10:11], v[240:241] op_sel:[0,1,1] op_sel_hi:[1,1,1]
    v_pk_fma_f32 v[110:111], v[206:207], s[10:11], v[240:241] op_sel_hi:[1,0,0]
    v_pk_fma_f32 v[206:207], v[206:207], s[10:11], v[240:241] op_sel:[0,1,1] op_sel_hi:[1,1,1]
    v_pk_fma_f32 v[112:113], v[208:209], s[10:11], v[240:241] op_sel_hi:[1,0,0]
    v_pk_fma_f32 v[208:209], v[208:209], s[10:11], v[240:241] op_sel:[0,1,1] op_sel_hi:[1,1,1]
    v_pk_fma_f32 v[114:115], v[210:211], s[10:11], v[240:241] op_sel_hi:[1,0,0]
    v_pk_fma_f32 v[210:211], v[210:211], s[10:11], v[240:241] op_sel:[0,1,1] op_sel_hi:[1,1,1]
    v_pk_fma_f32 v[116:117], v[212:213], s[10:11], v[240:241] op_sel_hi:[1,0,0]
    s_waitcnt vmcnt(1)
    v_cmp_ne_u64 vcc, s[70:71], v[20:21]
    s_cbranch_vccz L_pd2
    s_mov_b32 s95, 100000
L_pl2:
    buffer_load_dwordx2 v[20:21], v7, s[36:39], s27 offen sc1
    s_waitcnt vmcnt(0)
    v_cmp_ne_u64 vcc, s[70:71], v[20:21]
    s_cbranch_vccz L_pd2
    s_sub_u32 s95, s95, 1
    s_cbranch_scc0 L_pl2
L_pd2:
    buffer_load_dwordx4 v[88:91], v30, s[36:39], s84 offen sc1
    v_pk_fma_f32 v[212:213], v[212:213], s[10:11], v[240:241] op_sel:[0,1,1] op_sel_hi:[1,1,1]
    v_pk_fma_f32 v[118:119], v[214:215], s[10:11], v[240:241] op_sel_hi:[1,0,0]
    v_pk_fma_f32 v[214:215], v[214:215], s[10:11], v[240:241] op_sel:[0,1,1] op_sel_hi:[1,1,1]
    v_pk_fma_f32 v[120:121], v[216:217], s[10:11], v[240:241] op_sel_hi:[1,0,0]
    v_pk_fma_f32 v[216:217], v[216:217], s[10:11], v[240:241] op_sel:[0,1,1] op_sel_hi:[1,1,1]
    s_add_u32 s84, s84, 3584
    buffer_load_dwordx4 v[92:95], v30, s[36:39], s84 offen sc1
    v_pk_fma_f32 v[122:123], v[218:219], s[10:11], v[240:241] op_sel_hi:[1,0,0]
    v_pk_fma_f32 v[218:219], v[218:219], s[10:11], v[240:241] op_sel:[0,1,1] op_sel_hi:[1,1,1]
    v_exp_f32 v104, v104
    v_exp_f32 v200, v200
    v_exp_f32 v105, v105
    v_exp_f32 v201, v201
    s_add_u32 s84, s84, 3584
    buffer_load_dwordx4 v[96:99], v30, s[36:39], s84 offen sc1
    v_exp_f32 v106, v106
    v_exp_f32 v202, v202
    v_exp_f32 v107, v107
    v_exp_f32 v203, v203
    v_exp_f32 v108, v108
    s_add_u32 s84, s84, 3584
    buffer_load_dwordx4 v[100:103], v30, s[36:39], s84 offen sc1
    v_exp_f32 v204, v204
    v_exp_f32 v109, v109
    v_exp_f32 v205, v205
    v_exp_f32 v110, v110
    v_exp_f32 v206, v206
    v_exp_f32 v111, v111
    s_add_u32 s84, s84, 3584
    buffer_load_dwordx4 v[140:143], v30, s[36:39], s84 offen sc1
    v_exp_f32 v207, v207
    v_exp_f32 v112, v112
    v_exp_f32 v208, v208
    v_exp_f32 v113, v113
    v_exp_f32 v209, v209
    v_exp_f32 v114, v114
    s_add_u32 s84, s84, 3584
    buffer_load_dwordx4 v[144:147], v30, s[36:39], s84 offen sc1
    v_exp_f32 v210, v210
    v_exp_f32 v115, v115
    v_exp_f32 v211, v211
    v_exp_f32 v116, v116
    v_exp_f32 v212, v212
    s_add_u32 s84, s84, 3584
    buffer_load_dwordx4 v[148:151], v30, s[36:39], s84 offen sc1
    v_exp_f32 v117, v117
    v_exp_f32 v213, v213
    v_exp_f32 v118, v118
    v_exp_f32 v214, v214
    v_exp_f32 v119, v119
    v_exp_f32 v215, v215
    s_add_u32 s84, s84, 3584
    buffer_load_dwordx4 v[152:155], v30, s[36:39], s84 offen sc1
    v_exp_f32 v120, v120
    v_exp_f32 v216, v216
    v_exp_f32 v121, v121
    v_exp_f32 v217, v217
    v_exp_f32 v122, v122
    v_exp_f32 v218, v218
    s_add_u32 s84, s84, 3584
    buffer_load_dwordx4 v[156:159], v30, s[36:39], s84 offen sc1
    v_exp_f32 v123, v123
    v_exp_f32 v219, v219
    v_pk_add_f32 v[242:243], v[104:105], v[106:107]
    v_pk_add_f32 v[244:245], v[200:201], v[202:203]
    v_pk_add_f32 v[242:243], v[242:243], v[108:109]
    s_add_u32 s84, s84, 3584
    buffer_load_dwordx4 v[160:163], v30, s[36:39], s84 offen sc1
    v_pk_add_f32 v[244:245], v[244:245], v[204:205]
    v_pk_add_f32 v[242:243], v[242:243], v[110:111]
    v_pk_add_f32 v[244:245], v[244:245], v[206:207]
    v_pk_add_f32 v[242:243], v[242:243], v[112:113]
    v_pk_add_f32 v[244:245], v[244:245], v[208:209]
    v_pk_add_f32 v[242:243], v[242:243], v[114:115]
    s_add_u32 s84, s84, 3584
    buffer_load_dwordx4 v[164:167], v30, s[36:39], s84 offen sc1
    v_pk_add_f32 v[244:245], v[244:245], v[210:211]
    v_pk_add_f32 v[242:243], v[242:243], v[116:117]
    v_pk_add_f32 v[244:245], v[244:245], v[212:213]
    v_pk_add_f32 v[242:243], v[242:243], v[118:119]
    v_pk_add_f32 v[244:245], v[244:245], v[214:215]
    s_add_u32 s84, s84, 3584
    buffer_load_dwordx4 v[168:171], v30, s[36:39], s84 offen sc1
    v_pk_add_f32 v[242:243], v[242:243], v[120:121]
    v_pk_add_f32 v[244:245], v[244:245], v[216:217]
    v_pk_add_f32 v[242:243], v[242:243], v[122:123]
    v_pk_add_f32 v[244:245], v[244:245], v[218:219]
    v_add_f32 v242, v242, v243
    v_add_f32 v244, v244, v245
    s_add_u32 s84, s84, 3584
    buffer_load_dwordx4 v[172:175], v30, s[36:39], s84 offen sc1
    v_rcp_f32 v242, v242
    v_rcp_f32 v244, v244
    v_pk_mul_f32 v[104:105], v[104:105], v[242:243] op_sel_hi:[1,0]
    v_pk_mul_f32 v[106:107], v[106:107], v[242:243] op_sel_hi:[1,0]
    v_pk_mul_f32 v[108:109], v[108:109], v[242:243] op_sel_hi:[1,0]
    v_pk_mul_f32 v[110:111], v[110:111], v[242:243] op_sel_hi:[1,0]
    s_add_u32 s84, s84, 3584
    buffer_load_dwordx4 v[176:179], v30, s[36:39], s84 offen sc1
    v_pk_mul_f32 v[112:113], v[112:113], v[242:243] op_sel_hi:[1,0]
    v_pk_mul_f32 v[114:115], v[114:115], v[242:243] op_sel_hi:[1,0]
    v_pk_mul_f32 v[116:117], v[116:117], v[242:243] op_sel_hi:[1,0]
    v_pk_mul_f32 v[118:119], v[118:119], v[242:243] op_sel_hi:[1,0]
    v_pk_mul_f32 v[120:121], v[120:121], v[242:243] op_sel_hi:[1,0]
    s_add_u32 s84, s84, 3584
    buffer_load_dwordx4 v[248:251], v30, s[36:39], s84 offen sc1
    v_pk_mul_f32 v[122:123], v[122:123], v[242:243] op_sel_hi:[1,0]
    v_cvt_pk_bf16_f32 v64, v104, v105
    v_cvt_pk_bf16_f32 v65, v106, v107
    v_cvt_pk_bf16_f32 v68, v108, v109
    v_cvt_pk_bf16_f32 v69, v110, v111
    v_cvt_pk_bf16_f32 v72, v112, v113
    s_add_u32 s84, s84, 3584
    buffer_load_dwordx4 v[252:255], v30, s[36:39], s84 offen sc1
    v_cvt_pk_bf16_f32 v73, v114, v115
    v_cvt_pk_bf16_f32 v76, v116, v117
    v_cvt_pk_bf16_f32 v77, v118, v119
    v_cvt_pk_bf16_f32 v66, v120, v121
    v_cvt_pk_bf16_f32 v67, v122, v123
    v_pk_mul_f32 v[200:201], v[200:201], v[244:245] op_sel_hi:[1,0]
    v_pk_mul_f32 v[202:203], v[202:203], v[244:245] op_sel_hi:[1,0]
    v_pk_mul_f32 v[204:205], v[204:205], v[244:245] op_sel_hi:[1,0]
    s_add_u32 s23, s22, 32768
    s_add_u32 m0, s23, 0
    s_add_u32 s23, s23, s21
    s_add_u32 s60, s36, s23
    s_addc_u32 s61, s37, 0
    global_load_lds_dwordx4 v1, s[60:61] offset:1024 sc1
    v_pk_mul_f32 v[206:207], v[206:207], v[244:245] op_sel_hi:[1,0]
    v_pk_mul_f32 v[208:209], v[208:209], v[244:245] op_sel_hi:[1,0]
    v_pk_mul_f32 v[210:211], v[210:211], v[244:245] op_sel_hi:[1,0]
    v_pk_mul_f32 v[212:213], v[212:213], v[244:245] op_sel_hi:[1,0]
    global_load_lds_dwordx4 v1, s[60:61] offset:2048 sc1
    v_pk_mul_f32 v[214:215], v[214:215], v[244:245] op_sel_hi:[1,0]
    v_pk_mul_f32 v[216:217], v[216:217], v[244:245] op_sel_hi:[1,0]
    v_pk_mul_f32 v[218:219], v[218:219], v[244:245] op_sel_hi:[1,0]
    v_cvt_pk_bf16_f32 v70, v200, v201
    v_cvt_pk_bf16_f32 v71, v202, v203
    global_load_lds_dwordx4 v1, s[60:61] offset:3072 sc1
    v_cvt_pk_bf16_f32 v74, v204, v205
    v_cvt_pk_bf16_f32 v75, v206, v207
    v_cvt_pk_bf16_f32 v78, v208, v209
    v_cvt_pk_bf16_f32 v79, v210, v211
    s_add_u32 s23, s22, 49152
    s_add_u32 m0, s23, 0
    s_add_u32 s23, s23, s21
    s_add_u32 s60, s36, s23
    s_addc_u32 s61, s37, 0
    global_load_lds_dwordx4 v1, s[60:61] offset:0 sc1
    v_cvt_pk_bf16_f32 v80, v212, v213
    v_cvt_pk_bf16_f32 v81, v214, v215
    v_cvt_pk_bf16_f32 v82, v216, v217
    v_cvt_pk_bf16_f32 v83, v218, v219
    s_waitcnt vmcnt(19)
    v_lshlrev_b32 v184, 16, v88
    v_and_b32 v185, 4294901760, v88
    v_lshlrev_b32 v186, 16, v89
    v_and_b32 v187, 4294901760, v89
    v_lshlrev_b32 v188, 16, v90
    v_and_b32 v189, 4294901760, v90
    v_lshlrev_b32 v190, 16, v91
    v_and_b32 v191, 4294901760, v91
    s_waitcnt vmcnt(18)
    v_dot2_f32_bf16 v184, v92, s92, v184
    v_dot2_f32_bf16 v185, v92, s93, v185
    v_dot2_f32_bf16 v186, v93, s92, v186
    v_dot2_f32_bf16 v187, v93, s93, v187
    v_dot2_f32_bf16 v188, v94, s92, v188
    v_dot2_f32_bf16 v189, v94, s93, v189
    v_dot2_f32_bf16 v190, v95, s92, v190
    v_dot2_f32_bf16 v191, v95, s93, v191
    s_waitcnt vmcnt(17)
    v_dot2_f32_bf16 v184, v96, s92, v184
    v_dot2_f32_bf16 v185, v96, s93, v185
    v_dot2_f32_bf16 v186, v97, s92, v186
    v_dot2_f32_bf16 v187, v97, s93, v187
    v_dot2_f32_bf16 v188, v98, s92, v188
    v_dot2_f32_bf16 v189, v98, s93, v189
    v_dot2_f32_bf16 v190, v99, s92, v190
    v_dot2_f32_bf16 v191, v99, s93, v191
    s_waitcnt vmcnt(16)
    v_dot2_f32_bf16 v184, v100, s92, v184
    v_dot2_f32_bf16 v185, v100, s93, v185
    v_dot2_f32_bf16 v186, v101, s92, v186
    v_dot2_f32_bf16 v187, v101, s93, v187
    v_dot2_f32_bf16 v188, v102, s92, v188
    v_dot2_f32_bf16 v189, v102, s93, v189
    v_dot2_f32_bf16 v190, v103, s92, v190
    v_dot2_f32_bf16 v191, v103, s93, v191
    s_waitcnt vmcnt(15)
    v_dot2_f32_bf16 v184, v140, s92, v184
    v_dot2_f32_bf16 v185, v140, s93, v185
    v_dot2_f32_bf16 v186, v141, s92, v186
    v_dot2_f32_bf16 v187, v141, s93, v187
    v_dot2_f32_bf16 v188, v142, s92, v188
    v_dot2_f32_bf16 v189, v142, s93, v189
    v_dot2_f32_bf16 v190, v143, s92, v190
    v_dot2_f32_bf16 v191, v143, s93, v191
    s_waitcnt vmcnt(14)
    v_dot2_f32_bf16 v184, v144, s92, v184
    s_add_u32 s23, s22, 49152
    s_add_u32 m0, s23, 0
    s_add_u32 s23, s23, s21
    s_add_u32 s60, s36, s23
    s_addc_u32 s61, s37, 0
    global_load_lds_dwordx4 v1, s[60:61] offset:1024 sc1
    v_dot2_f32_bf16 v185, v144, s93, v185
    v_dot2_f32_bf16 v186, v145, s92, v186
    v_dot2_f32_bf16 v187, v145, s93, v187
    v_dot2_f32_bf16 v188, v146, s92, v188
    v_dot2_f32_bf16 v189, v146, s93, v189
    v_dot2_f32_bf16 v190, v147, s92, v190
    v_dot2_f32_bf16 v191, v147, s93, v191
    s_waitcnt vmcnt(14)
    v_dot2_f32_bf16 v184, v148, s92, v184
    v_dot2_f32_bf16 v185, v148, s93, v185
    v_dot2_f32_bf16 v186, v149, s92, v186
    v_dot2_f32_bf16 v187, v149, s93, v187
    v_dot2_f32_bf16 v188, v150, s92, v188
    v_dot2_f32_bf16 v189, v150, s93, v189
    v_dot2_f32_bf16 v190, v151, s92, v190
    v_dot2_f32_bf16 v191, v151, s93, v191
    s_waitcnt vmcnt(13)
    v_dot2_f32_bf16 v184, v152, s92, v184
    v_dot2_f32_bf16 v185, v152, s93, v185
    v_dot2_f32_bf16 v186, v153, s92, v186
    v_dot2_f32_bf16 v187, v153, s93, v187
    v_dot2_f32_bf16 v188, v154, s92, v188
    v_dot2_f32_bf16 v189, v154, s93, v189
    v_dot2_f32_bf16 v190, v155, s92, v190
    global_load_lds_dwordx4 v1, s[60:61] offset:2048 sc1
    v_dot2_f32_bf16 v191, v155, s93, v191
    s_waitcnt vmcnt(13)
    v_dot2_f32_bf16 v184, v156, s92, v184
    v_dot2_f32_bf16 v185, v156, s93, v185
    v_dot2_f32_bf16 v186, v157, s92, v186
    v_dot2_f32_bf16 v187, v157, s93, v187
    v_dot2_f32_bf16 v188, v158, s92, v188
    v_dot2_f32_bf16 v189, v158, s93, v189
    v_dot2_f32_bf16 v190, v159, s92, v190
    v_dot2_f32_bf16 v191, v159, s93, v191
    s_waitcnt vmcnt(12)
    v_dot2_f32_bf16 v184, v160, s92, v184
    v_dot2_f32_bf16 v185, v160, s93, v185
    v_dot2_f32_bf16 v186, v161, s92, v186
    v_dot2_f32_bf16 v187, v161, s93, v187
    v_dot2_f32_bf16 v188, v162, s92, v188
    v_dot2_f32_bf16 v189, v162, s93, v189
    v_dot2_f32_bf16 v190, v163, s92, v190
    v_dot2_f32_bf16 v191, v163, s93, v191
    s_waitcnt vmcnt(11)
    v_dot2_f32_bf16 v184, v164, s92, v184
    v_dot2_f32_bf16 v185, v164, s93, v185
    v_dot2_f32_bf16 v186, v165, s92, v186
    v_dot2_f32_bf16 v187, v165, s93, v187
    v_dot2_f32_bf16 v188, v166, s92, v188
    global_load_lds_dwordx4 v1, s[60:61] offset:3072 sc1
    v_dot2_f32_bf16 v189, v166, s93, v189
    v_dot2_f32_bf16 v190, v167, s92, v190
    v_dot2_f32_bf16 v191, v167, s93, v191
    s_waitcnt vmcnt(11)
    v_dot2_f32_bf16 v184, v168, s92, v184
    v_dot2_f32_bf16 v185, v168, s93, v185
    v_dot2_f32_bf16 v186, v169, s92, v186
    v_dot2_f32_bf16 v187, v169, s93, v187
    v_dot2_f32_bf16 v188, v170, s92, v188
    v_dot2_f32_bf16 v189, v170, s93, v189
    v_dot2_f32_bf16 v190, v171, s92, v190
    v_dot2_f32_bf16 v191, v171, s93, v191
    s_waitcnt vmcnt(10)
    v_dot2_f32_bf16 v184, v172, s92, v184
    v_dot2_f32_bf16 v185, v172, s93, v185
    v_dot2_f32_bf16 v186, v173, s92, v186
    v_dot2_f32_bf16 v187, v173, s93, v187
    v_dot2_f32_bf16 v188, v174, s92, v188
    v_dot2_f32_bf16 v189, v174, s93, v189
    v_dot2_f32_bf16 v190, v175, s92, v190
    v_dot2_f32_bf16 v191, v175, s93, v191
    s_waitcnt vmcnt(9)
    v_dot2_f32_bf16 v184, v176, s92, v184
    v_dot2_f32_bf16 v185, v176, s93, v185
    v_dot2_f32_bf16 v186, v177, s92, v186
    buffer_load_dwordx2 v[18:19], v22, s[36:39], s26 offen sc1
    v_dot2_f32_bf16 v187, v177, s93, v187
    v_dot2_f32_bf16 v188, v178, s92, v188
    v_dot2_f32_bf16 v189, v178, s93, v189
    v_dot2_f32_bf16 v190, v179, s92, v190
    v_dot2_f32_bf16 v191, v179, s93, v191
    s_waitcnt vmcnt(9)
    v_dot2_f32_bf16 v184, v248, s92, v184
    v_dot2_f32_bf16 v185, v248, s93, v185
    v_dot2_f32_bf16 v186, v249, s92, v186
    v_dot2_f32_bf16 v187, v249, s93, v187
    v_dot2_f32_bf16 v188, v250, s92, v188
    v_dot2_f32_bf16 v189, v250, s93, v189
    v_dot2_f32_bf16 v190, v251, s92, v190
    v_dot2_f32_bf16 v191, v251, s93, v191
    s_waitcnt vmcnt(8)
    v_dot2_f32_bf16 v184, v252, s92, v184
    v_dot2_f32_bf16 v185, v252, s93, v185
    v_dot2_f32_bf16 v186, v253, s92, v186
    v_dot2_f32_bf16 v187, v253, s93, v187
    v_dot2_f32_bf16 v188, v254, s92, v188
    v_dot2_f32_bf16 v189, v254, s93, v189
    v_dot2_f32_bf16 v190, v255, s92, v190
    v_dot2_f32_bf16 v191, v255, s93, v191
    v_cvt_pk_bf16_f32 v192, v184, v185
    v_cvt_pk_bf16_f32 v193, v186, v187
    v_cvt_pk_bf16_f32 v194, v188, v189
    v_cvt_pk_bf16_f32 v195, v190, v191
    ds_write_b128 v31, v[192:195]
    s_waitcnt lgkmcnt(0)
    s_barrier
    ds_read_b128 v[104:107], v32 offset:1344
    ds_read_b128 v[108:111], v32 offset:0
    ds_read_b128 v[112:115], v32 offset:64
    ds_read_b128 v[116:119], v32 offset:128
    ds_read_b128 v[120:123], v32 offset:192
    ds_read_b128 v[124:127], v32 offset:1280
    ds_read_b128 v[128:131], v32 offset:1424
    ds_read_b128 v[132:135], v32 offset:256
    s_waitcnt lgkmcnt(7)
    v_mfma_f32_16x16x32_bf16 v[244:247], v[104:107], v[64:67], 0
    ds_read_b128 v[136:139], v32 offset:320
    s_waitcnt lgkmcnt(7)
    v_mfma_f32_16x16x32_bf16 v[224:227], v[108:111], v[64:67], 0
    ds_read_b128 v[140:143], v32 offset:384
    s_waitcnt lgkmcnt(7)
    v_mfma_f32_16x16x32_bf16 v[228:231], v[112:115], v[64:67], 0
    ds_read_b128 v[144:147], v32 offset:448
    s_waitcnt lgkmcnt(7)
    v_mfma_f32_16x16x32_bf16 v[232:235], v[116:119], v[64:67], 0
    ds_read_b128 v[148:151], v32 offset:1360
    s_waitcnt vmcnt(0)
    v_cmp_ne_u64 vcc, s[70:71], v[18:19]
    s_cbranch_vccz L_pd3
    s_mov_b32 s95, 100000
L_pl3:
    buffer_load_dwordx2 v[18:19], v22, s[36:39], s26 offen sc1
    s_waitcnt vmcnt(0)
    v_cmp_ne_u64 vcc, s[70:71], v[18:19]
    s_cbranch_vccz L_pd3
    s_sub_u32 s95, s95, 1
    s_cbranch_scc0 L_pl3
L_pd3:
    s_add_u32 s62, s36, s24
    s_addc_u32 s63, s37, 0
    global_load_dwordx4 a[0:3], v1, s[62:63] offset:0 sc1
    s_waitcnt lgkmcnt(7)
    v_mfma_f32_16x16x32_bf16 v[236:239], v[120:123], v[64:67], 0
    ds_read_b128 v[152:155], v32 offset:1504
    s_waitcnt lgkmcnt(7)
    v_mfma_f32_16x16x32_bf16 v[240:243], v[124:127], v[64:67], 0
    ds_read_b128 v[156:159], v32 offset:512
    s_waitcnt lgkmcnt(7)
    v_mfma_f32_16x16x32_bf16 v[244:247], v[128:131], v[68:71], v[244:247]
    ds_read_b128 v[160:163], v32 offset:576
    s_waitcnt lgkmcnt(7)
    v_mfma_f32_16x16x32_bf16 v[224:227], v[132:135], v[68:71], v[224:227]
    ds_read_b128 v[164:167], v32 offset:640
    global_load_dwordx4 a[4:7], v1, s[62:63] offset:1024 sc1
    s_waitcnt lgkmcnt(7)
    v_mfma_f32_16x16x32_bf16 v[228:231], v[136:139], v[68:71], v[228:231]
    ds_read_b128 v[168:171], v32 offset:704
    s_waitcnt lgkmcnt(7)
    v_mfma_f32_16x16x32_bf16 v[232:235], v[140:143], v[68:71], v[232:235]
    ds_read_b128 v[172:175], v32 offset:1440
    s_waitcnt lgkmcnt(7)
    v_mfma_f32_16x16x32_bf16 v[236:239], v[144:147], v[68:71], v[236:239]
    ds_read_b128 v[176:179], v32 offset:1584
    s_waitcnt lgkmcnt(7)
    v_mfma_f32_16x16x32_bf16 v[240:243], v[148:151], v[68:71], v[240:243]
    ds_read_b128 v[180:183], v32 offset:768
    global_load_dwordx4 a[8:11], v1, s[62:63] offset:2048 sc1
    s_waitcnt lgkmcnt(7)
    v_mfma_f32_16x16x32_bf16 v[244:247], v[152:155], v[72:75], v[244:247]
    ds_read_b128 v[184:187], v32 offset:832
    s_waitcnt lgkmcnt(7)
    v_mfma_f32_16x16x32_bf16 v[224:227], v[156:159], v[72:75], v[224:227]
    ds_read_b128 v[188:191], v32 offset:896
    s_waitcnt lgkmcnt(7)
    v_mfma_f32_16x16x32_bf16 v[228:231], v[160:163], v[72:75], v[228:231]
    ds_read_b128 v[192:195], v32 offset:960
    s_waitcnt lgkmcnt(7)
    v_mfma_f32_16x16x32_bf16 v[232:235], v[164:167], v[72:75], v[232:235]
    ds_read_b128 v[196:199], v32 offset:1520
    s_waitcnt lgkmcnt(7)
    v_mfma_f32_16x16x32_bf16 v[236:239], v[168:171], v[72:75], v[236:239]
    ds_read_b128 v[200:203], v32 offset:1664
    global_load_dwordx4 a[12:15], v1, s[62:63] offset:3072 sc1
    s_waitcnt lgkmcnt(7)
    v_mfma_f32_16x16x32_bf16 v[240:243], v[172:175], v[72:75], v[240:243]
    ds_read_b128 v[204:207], v32 offset:1024
    s_waitcnt lgkmcnt(7)
    v_mfma_f32_16x16x32_bf16 v[244:247], v[176:179], v[76:79], v[244:247]
    ds_read_b128 v[208:211], v32 offset:1088
    s_add_u32 s62, s24, 20480
    s_waitcnt lgkmcnt(7)
    v_mfma_f32_16x16x32_bf16 v[224:227], v[180:183], v[76:79], v[224:227]
    ds_read_b128 v[212:215], v32 offset:1152
    s_add_u32 s62, s36, s62
    s_addc_u32 s63, s37, 0
    s_waitcnt lgkmcnt(7)
    v_mfma_f32_16x16x32_bf16 v[228:231], v[184:187], v[76:79], v[228:231]
    ds_read_b128 v[216:219], v32 offset:1216
    global_load_dwordx4 a[80:83], v1, s[62:63] offset:0 sc1
    s_waitcnt lgkmcnt(7)
    v_mfma_f32_16x16x32_bf16 v[232:235], v[188:191], v[76:79], v[232:235]
    ds_read_b128 v[220:223], v32 offset:1600
    s_waitcnt lgkmcnt(7)
    v_mfma_f32_16x16x32_bf16 v[236:239], v[192:195], v[76:79], v[236:239]
    s_waitcnt lgkmcnt(6)
    v_mfma_f32_16x16x32_bf16 v[240:243], v[196:199], v[76:79], v[240:243]
    s_waitcnt lgkmcnt(5)
    v_mfma_f32_16x16x32_bf16 v[244:247], v[200:203], v[80:83], v[244:247]
    global_load_dwordx4 a[84:87], v1, s[62:63] offset:1024 sc1
    s_waitcnt lgkmcnt(4)
    v_mfma_f32_16x16x32_bf16 v[224:227], v[204:207], v[80:83], v[224:227]
    s_waitcnt lgkmcnt(3)
    v_mfma_f32_16x16x32_bf16 v[228:231], v[208:211], v[80:83], v[228:231]
    s_waitcnt lgkmcnt(2)
    v_mfma_f32_16x16x32_bf16 v[232:235], v[212:215], v[80:83], v[232:235]
    s_waitcnt lgkmcnt(1)
    v_mfma_f32_16x16x32_bf16 v[236:239], v[216:219], v[80:83], v[236:239]
    s_waitcnt lgkmcnt(0)
    v_mfma_f32_16x16x32_bf16 v[240:243], v[220:223], v[80:83], v[240:243]
    v_add_f32 v244, s9, v244
    v_rcp_f32 v244, v244
    s_nop 0
    v_pk_mul_f32 v[224:225], v[224:225], v[244:245] op_sel_hi:[1,0]
    v_pk_mul_f32 v[226:227], v[226:227], v[244:245] op_sel_hi:[1,0]
    v_pk_mul_f32 v[228:229], v[228:229], v[244:245] op_sel_hi:[1,0]
    v_pk_mul_f32 v[230:231], v[230:231], v[244:245] op_sel_hi:[1,0]
    v_pk_mul_f32 v[232:233], v[232:233], v[244:245] op_sel_hi:[1,0]
    v_pk_mul_f32 v[234:235], v[234:235], v[244:245] op_sel_hi:[1,0]
    v_pk_mul_f32 v[236:237], v[236:237], v[244:245] op_sel_hi:[1,0]
    v_pk_mul_f32 v[238:239], v[238:239], v[244:245] op_sel_hi:[1,0]
    v_pk_mul_f32 v[240:241], v[240:241], v[244:245] op_sel_hi:[1,0]
    v_pk_mul_f32 v[242:243], v[242:243], v[244:245] op_sel_hi:[1,0]
    v_cvt_pk_bf16_f32 v84, v224, v225
    v_cvt_pk_bf16_f32 v85, v226, v227
    v_cvt_pk_bf16_f32 v86, v228, v229
    v_cvt_pk_bf16_f32 v87, v230, v231
    v_cvt_pk_bf16_f32 v88, v232, v233
    v_cvt_pk_bf16_f32 v89, v234, v235
    v_cvt_pk_bf16_f32 v90, v236, v237
    v_cvt_pk_bf16_f32 v91, v238, v239
    v_cvt_pk_bf16_f32 v92, v240, v241
    v_cvt_pk_bf16_f32 v93, v242, v243
    buffer_store_dwordx4 v[84:87], v44, s[36:39], s87 offen sc1
    buffer_store_dwordx4 v[88:91], v44, s[36:39], s87 offen offset:256 sc1
    buffer_store_dwordx2 v[92:93], v45, s[36:39], s87 offen offset:1024 sc1
    s_lshl_b32 s99, s67, 1
    s_add_u32 s99, s99, s69
    s_lshl_b32 s72, s64, 3
    s_add_u32 s100, s72, s99
    s_mul_i32 s98, s100, 20480
    s_mul_i32 s72, s68, 160
    s_add_u32 s98, s98, s72
    v_add_u32 v11, 0, v16
    v_mul_u32_u24 v12, 205, v11
    v_lshrrev_b32 v12, 11, v12
    v_mul_u32_u24 v13, 10, v12
    v_sub_u32 v13, v11, v13
    v_mul_u32_u24 v168, 1280, v12
    v_lshl_add_u32 v168, v13, 4, v168
    v_add_u32 v11, 64, v16
    v_mul_u32_u24 v12, 205, v11
    v_lshrrev_b32 v12, 11, v12
    v_mul_u32_u24 v13, 10, v12
    v_sub_u32 v13, v11, v13
    v_mul_u32_u24 v169, 1280, v12
    v_lshl_add_u32 v169, v13, 4, v169
    v_subrev_u32 v169, 1024, v169
    v_add_u32 v11, 128, v16
    v_mul_u32_u24 v12, 205, v11
    v_lshrrev_b32 v12, 11, v12
    v_mul_u32_u24 v13, 10, v12
    v_sub_u32 v13, v11, v13
    v_mul_u32_u24 v170, 1280, v12
    v_lshl_add_u32 v170, v13, 4, v170
    v_subrev_u32 v170, 2048, v170
    s_waitcnt vmcnt(0)
    s_barrier
    s_lshl_b32 s72, s64, 11
    s_lshl_b32 s73, s65, 7
    s_add_u32 s72, s72, s73
    s_add_u32 s72, s72, 69632
    buffer_store_dwordx2 v[8:9], v5, s[36:39], s72 offen sc1
    s_mul_i32 s74, s67, 3072
    s_add_u32 m0, s74, 114688
    s_nop 0
    buffer_load_dwordx4 v168, s[28:31], s98 offen offset:0 lds
    buffer_load_dwordx4 v169, s[28:31], s98 offen offset:1024 lds
    buffer_load_dwordx4 v170, s[28:31], s98 offen offset:2048 lds
    v_mul_u32_u24 v168, 160, v3
    v_mul_u32_u24 v11, 40, v2
    v_add3_u32 v168, v168, v11, s74
    v_add_u32 v168, 114688, v168
    v_add_u32 v11, 0, v1
    v_add_u32 v12, 61440, v1
    v_mov_b32 v38, v168
    s_mul_i32 s17, s100, 20480
    s_add_u32 s17, s17, 2097152
    s_lshl_b32 s18, s64, 11
    s_add_u32 s18, s18, 69632
    s_add_u32 s62, s24, 20480
    s_add_u32 s62, s36, s62
    s_addc_u32 s63, s37, 0
    global_load_dwordx4 a[88:91], v1, s[62:63] offset:2048 sc1
    global_load_dwordx4 a[92:95], v1, s[62:63] offset:3072 sc1
    s_add_u32 s62, s24, 40960
    s_add_u32 s62, s36, s62
    s_addc_u32 s63, s37, 0
    global_load_dwordx4 a[160:163], v1, s[62:63] offset:0 sc1
    global_load_dwordx4 a[164:167], v1, s[62:63] offset:1024 sc1
    s_waitcnt vmcnt(4)
    s_barrier
    s_add_u32 s62, s24, 40960
    s_add_u32 s62, s36, s62
    s_addc_u32 s63, s37, 0
    global_load_dwordx4 a[168:171], v1, s[62:63] offset:2048 sc1
    global_load_dwordx4 a[172:175], v1, s[62:63] offset:3072 sc1
    s_add_u32 s62, s24, 4096
    s_add_u32 s62, s36, s62
    s_addc_u32 s63, s37, 0
    global_load_dwordx4 a[16:19], v1, s[62:63] offset:0 sc1
    global_load_dwordx4 a[20:23], v1, s[62:63] offset:1024 sc1
    global_load_dwordx4 a[24:27], v1, s[62:63] offset:2048 sc1
    buffer_load_dwordx2 v[152:153], v6, s[36:39], s18 offen sc1
    s_add_u32 s62, s24, 4096
    s_add_u32 s62, s36, s62
    s_addc_u32 s63, s37, 0
    global_load_dwordx4 a[28:31], v1, s[62:63] offset:3072 sc1
    s_add_u32 s62, s24, 24576
    s_add_u32 s62, s36, s62
    s_addc_u32 s63, s37, 0
    global_load_dwordx4 a[96:99], v1, s[62:63] offset:0 sc1
    global_load_dwordx4 a[100:103], v1, s[62:63] offset:1024 sc1
    global_load_dwordx4 a[104:107], v1, s[62:63] offset:2048 sc1
    global_load_dwordx4 a[108:111], v1, s[62:63] offset:3072 sc1
    s_add_u32 s62, s24, 45056
    s_add_u32 s62, s36, s62
    s_addc_u32 s63, s37, 0
    global_load_dwordx4 a[176:179], v1, s[62:63] offset:0 sc1
    ds_read_b64 v[28:29], v38 offset:0
    ds_read_b64 v[30:31], v38 offset:8
    ds_read_b64 v[32:33], v38 offset:16
    ds_read_b64 v[34:35], v38 offset:24
    ds_read_b64 v[36:37], v38 offset:32
    ds_read_b128 v[172:175], v11 offset:0
    ds_read_b128 v[176:179], v11 offset:1024
    ds_read_b128 v[180:183], v11 offset:2048
    ds_read_b128 v[184:187], v11 offset:3072
    ds_read_b128 v[188:191], v11 offset:4096
    ds_read_b128 v[192:195], v11 offset:5120
    ds_read_b128 v[196:199], v11 offset:6144
    ds_read_b128 v[200:203], v11 offset:7168
    ds_read_b128 v[204:207], v11 offset:8192
    ds_read_b128 v[208:211], v11 offset:9216
    ds_read_b128 v[212:215], v11 offset:10240
    ds_read_b128 v[216:219], v11 offset:11264
    ds_read_b128 v[220:223], v11 offset:12288
    ds_read_b128 v[224:227], v11 offset:13312
    ds_read_b128 v[228:231], v11 offset:14336
    ds_read_b128 v[232:235], v11 offset:15360
    ds_read_b128 v[236:239], v11 offset:16384
    ds_read_b128 v[240:243], v11 offset:17408
    ds_read_b128 v[244:247], v11 offset:18432
    ds_read_b128 v[248:251], v11 offset:19456
    ds_read_b128 v[252:255], v11 offset:20480
    ds_read_b128 v[120:123], v11 offset:21504
    ds_read_b128 v[124:127], v11 offset:22528
    ds_read_b128 v[128:131], v11 offset:23552
    ds_read_b128 v[132:135], v11 offset:24576
    ds_read_b128 v[136:139], v11 offset:25600
    ds_read_b128 v[140:143], v11 offset:26624
    ds_read_b128 v[144:147], v11 offset:27648
    ds_read_b128 v[148:151], v11 offset:28672
    s_waitcnt vmcnt(6)
    v_cmp_ne_u64 vcc, s[70:71], v[152:153]
    s_cbranch_vccz L_pd4
    s_mov_b32 s95, 100000
L_pl4:
    buffer_load_dwordx2 v[152:153], v6, s[36:39], s18 offen sc1
    s_waitcnt vmcnt(0)
    v_cmp_ne_u64 vcc, s[70:71], v[152:153]
    s_cbranch_vccz L_pd4
    s_sub_u32 s95, s95, 1
    s_cbranch_scc0 L_pl4
L_pd4:
    s_add_u32 s32, s17, 4096
    s_add_u32 s32, s36, s32
    s_addc_u32 s33, s37, 0
    global_load_dwordx4 v[40:43], v1, s[32:33] offset:-4096 sc1
    global_load_dwordx4 v[44:47], v1, s[32:33] offset:-3072 sc1
    global_load_dwordx4 v[48:51], v1, s[32:33] offset:-2048 sc1
    global_load_dwordx4 v[52:55], v1, s[32:33] offset:-1024 sc1
    global_load_dwordx4 v[56:59], v1, s[32:33] offset:0 sc1
    global_load_dwordx4 v[60:63], v1, s[32:33] offset:1024 sc1
    global_load_dwordx4 v[64:67], v1, s[32:33] offset:2048 sc1
    global_load_dwordx4 v[68:71], v1, s[32:33] offset:3072 sc1
    s_add_u32 s32, s17, 12288
    s_add_u32 s32, s36, s32
    s_addc_u32 s33, s37, 0
    global_load_dwordx4 v[72:75], v1, s[32:33] offset:-4096 sc1
    global_load_dwordx4 v[76:79], v1, s[32:33] offset:-3072 sc1
    s_waitcnt lgkmcnt(15)
    v_lshlrev_b32 v152, 16, v28
    v_and_b32 v153, 4294901760, v28
    v_lshlrev_b32 v154, 16, v29
    v_and_b32 v155, 4294901760, v29
    v_lshlrev_b32 v156, 16, v30
    v_and_b32 v157, 4294901760, v30
    v_lshlrev_b32 v158, 16, v31
    v_and_b32 v159, 4294901760, v31
    v_lshlrev_b32 v160, 16, v32
    v_and_b32 v161, 4294901760, v32
    v_lshlrev_b32 v162, 16, v33
    v_and_b32 v163, 4294901760, v33
    v_lshlrev_b32 v164, 16, v34
    v_and_b32 v165, 4294901760, v34
    v_lshlrev_b32 v166, 16, v35
    v_and_b32 v167, 4294901760, v35
    v_lshlrev_b32 v168, 16, v36
    v_and_b32 v169, 4294901760, v36
    v_lshlrev_b32 v170, 16, v37
    v_and_b32 v171, 4294901760, v37
    v_lshrrev_b32 v36, 1, v2
    v_mul_u32_u24 v36, 1280, v36
    v_lshl_add_u32 v36, v3, 4, v36
    v_and_b32 v38, 1, v2
    v_lshl_add_u32 v37, v38, 3, v36
    v_lshl_add_u32 v36, v38, 9, v36
    v_lshrrev_b32 v35, 1, v2
    v_lshlrev_b32 v35, 2, v35
    v_lshl_add_u32 v35, v3, 3, v35
    v_cmp_eq_u32 vcc, 0, v38
    v_mov_b32 v38, 1073741824
    s_nop 0
    v_cndmask_b32 v35, v38, v35, vcc
    s_mul_i32 s74, s100, 20480
    s_mul_i32 s73, s68, 2560
    s_add_u32 s74, s74, s73
    s_add_u32 s74, s74, 5242880
    s_lshl_b32 s75, s100, 10
    s_lshl_b32 s73, s68, 7
    s_add_u32 s75, s75, s73
    s_add_u32 s75, s75, 7864320
    s_waitcnt vmcnt(9)
    v_mfma_f32_16x16x32_bf16 v[152:155], v[172:175], v[40:43], v[152:155]
    ds_read_b128 v[172:175], v11 offset:29696
    s_add_u32 s32, s17, 12288
    v_mfma_f32_16x16x32_bf16 v[156:159], v[176:179], v[40:43], v[156:159]
    ds_read_b128 v[176:179], v11 offset:30720
    s_add_u32 s32, s36, s32
    s_addc_u32 s33, s37, 0
    v_mfma_f32_16x16x32_bf16 v[160:163], v[180:183], v[40:43], v[160:163]
    ds_read_b128 v[180:183], v11 offset:31744
    global_load_dwordx4 v[80:83], v1, s[32:33] offset:-2048 sc1
    v_mfma_f32_16x16x32_bf16 v[164:167], v[184:187], v[40:43], v[164:167]
    v_mfma_f32_16x16x32_bf16 v[168:171], v[188:191], v[40:43], v[168:171]
    ds_read_b128 v[184:187], v11 offset:32768
    s_waitcnt vmcnt(9)
    v_mfma_f32_16x16x32_bf16 v[152:155], v[192:195], v[44:47], v[152:155]
    ds_read_b128 v[188:191], v11 offset:33792
    v_mfma_f32_16x16x32_bf16 v[156:159], v[196:199], v[44:47], v[156:159]
    ds_read_b128 v[192:195], v11 offset:34816
    global_load_dwordx4 v[84:87], v1, s[32:33] offset:-1024 sc1
    v_mfma_f32_16x16x32_bf16 v[160:163], v[200:203], v[44:47], v[160:163]
    v_mfma_f32_16x16x32_bf16 v[164:167], v[204:207], v[44:47], v[164:167]
    ds_read_b128 v[196:199], v11 offset:35840
    v_mfma_f32_16x16x32_bf16 v[168:171], v[208:211], v[44:47], v[168:171]
    ds_read_b128 v[200:203], v11 offset:36864
    s_waitcnt vmcnt(9)
    v_mfma_f32_16x16x32_bf16 v[152:155], v[212:215], v[48:51], v[152:155]
    ds_read_b128 v[204:207], v11 offset:37888
    global_load_dwordx4 v[88:91], v1, s[32:33] offset:0 sc1
    v_mfma_f32_16x16x32_bf16 v[156:159], v[216:219], v[48:51], v[156:159]
    v_mfma_f32_16x16x32_bf16 v[160:163], v[220:223], v[48:51], v[160:163]
    ds_read_b128 v[208:211], v11 offset:38912
    v_mfma_f32_16x16x32_bf16 v[164:167], v[224:227], v[48:51], v[164:167]
    ds_read_b128 v[212:215], v11 offset:39936
    s_waitcnt lgkmcnt(5)
    v_mfma_f32_16x16x32_bf16 v[168:171], v[228:231], v[48:51], v[168:171]
    ds_read_b128 v[216:219], v11 offset:40960
    global_load_dwordx4 v[92:95], v1, s[32:33] offset:1024 sc1
    s_waitcnt vmcnt(10)
    v_mfma_f32_16x16x32_bf16 v[152:155], v[232:235], v[52:55], v[152:155]
    v_mfma_f32_16x16x32_bf16 v[156:159], v[236:239], v[52:55], v[156:159]
    ds_read_b128 v[220:223], v11 offset:41984
    v_mfma_f32_16x16x32_bf16 v[160:163], v[240:243], v[52:55], v[160:163]
    ds_read_b128 v[224:227], v11 offset:43008
    v_mfma_f32_16x16x32_bf16 v[164:167], v[244:247], v[52:55], v[164:167]
    ds_read_b128 v[228:231], v11 offset:44032
    global_load_dwordx4 v[96:99], v1, s[32:33] offset:2048 sc1
    v_mfma_f32_16x16x32_bf16 v[168:171], v[248:251], v[52:55], v[168:171]
    s_waitcnt vmcnt(10)
    v_mfma_f32_16x16x32_bf16 v[152:155], v[252:255], v[56:59], v[152:155]
    ds_read_b128 v[232:235], v11 offset:45056
    v_mfma_f32_16x16x32_bf16 v[156:159], v[120:123], v[56:59], v[156:159]
    ds_read_b128 v[236:239], v11 offset:46080
    v_mfma_f32_16x16x32_bf16 v[160:163], v[124:127], v[56:59], v[160:163]
    ds_read_b128 v[240:243], v11 offset:47104
    global_load_dwordx4 v[100:103], v1, s[32:33] offset:3072 sc1
    v_mfma_f32_16x16x32_bf16 v[164:167], v[128:131], v[56:59], v[164:167]
    s_add_u32 s32, s17, 20480
    s_add_u32 s32, s36, s32
    s_addc_u32 s33, s37, 0
    v_mfma_f32_16x16x32_bf16 v[168:171], v[132:135], v[56:59], v[168:171]
    ds_read_b128 v[244:247], v11 offset:48128
    s_waitcnt vmcnt(10)
    v_mfma_f32_16x16x32_bf16 v[152:155], v[136:139], v[60:63], v[152:155]
    ds_read_b128 v[248:251], v11 offset:49152
    v_mfma_f32_16x16x32_bf16 v[156:159], v[140:143], v[60:63], v[156:159]
    ds_read_b128 v[252:255], v11 offset:50176
    global_load_dwordx4 v[104:107], v1, s[32:33] offset:-4096 sc1
    v_mfma_f32_16x16x32_bf16 v[160:163], v[144:147], v[60:63], v[160:163]
    v_mfma_f32_16x16x32_bf16 v[164:167], v[148:151], v[60:63], v[164:167]
    ds_read_b128 v[120:123], v11 offset:51200
    v_mfma_f32_16x16x32_bf16 v[168:171], v[172:175], v[60:63], v[168:171]
    ds_read_b128 v[124:127], v11 offset:52224
    s_waitcnt vmcnt(10)
    v_mfma_f32_16x16x32_bf16 v[152:155], v[176:179], v[64:67], v[152:155]
    ds_read_b128 v[128:131], v11 offset:53248
    global_load_dwordx4 v[108:111], v1, s[32:33] offset:-3072 sc1
    v_mfma_f32_16x16x32_bf16 v[156:159], v[180:183], v[64:67], v[156:159]
    v_mfma_f32_16x16x32_bf16 v[160:163], v[184:187], v[64:67], v[160:163]
    ds_read_b128 v[132:135], v11 offset:54272
    v_mfma_f32_16x16x32_bf16 v[164:167], v[188:191], v[64:67], v[164:167]
    ds_read_b128 v[136:139], v11 offset:55296
    v_mfma_f32_16x16x32_bf16 v[168:171], v[192:195], v[64:67], v[168:171]
    ds_read_b128 v[140:143], v11 offset:56320
    global_load_dwordx4 v[112:115], v1, s[32:33] offset:-2048 sc1
    s_waitcnt vmcnt(11) lgkmcnt(6)
    v_mfma_f32_16x16x32_bf16 v[152:155], v[196:199], v[68:71], v[152:155]
    v_mfma_f32_16x16x32_bf16 v[156:159], v[200:203], v[68:71], v[156:159]
    ds_read_b128 v[144:147], v11 offset:57344
    v_mfma_f32_16x16x32_bf16 v[160:163], v[204:207], v[68:71], v[160:163]
    ds_read_b128 v[148:151], v11 offset:58368
    v_mfma_f32_16x16x32_bf16 v[164:167], v[208:211], v[68:71], v[164:167]
    ds_read_b128 v[172:175], v11 offset:59392
    global_load_dwordx4 v[116:119], v1, s[32:33] offset:-1024 sc1
    v_mfma_f32_16x16x32_bf16 v[168:171], v[212:215], v[68:71], v[168:171]
    s_waitcnt vmcnt(11)
    v_mfma_f32_16x16x32_bf16 v[152:155], v[216:219], v[72:75], v[152:155]
    ds_read_b128 v[176:179], v11 offset:60416
    v_mfma_f32_16x16x32_bf16 v[156:159], v[220:223], v[72:75], v[156:159]
    ds_read_b128 v[180:183], v12 offset:0
    v_mfma_f32_16x16x32_bf16 v[160:163], v[224:227], v[72:75], v[160:163]
    ds_read_b128 v[184:187], v12 offset:1024
    v_mfma_f32_16x16x32_bf16 v[164:167], v[228:231], v[72:75], v[164:167]
    v_mfma_f32_16x16x32_bf16 v[168:171], v[232:235], v[72:75], v[168:171]
    ds_read_b128 v[188:191], v12 offset:2048
    s_add_u32 s62, s24, 45056
    s_waitcnt vmcnt(10)
    v_mfma_f32_16x16x32_bf16 v[152:155], v[236:239], v[76:79], v[152:155]
    ds_read_b128 v[192:195], v12 offset:3072
    s_add_u32 s62, s36, s62
    s_addc_u32 s63, s37, 0
    v_mfma_f32_16x16x32_bf16 v[156:159], v[240:243], v[76:79], v[156:159]
    ds_read_b128 v[196:199], v12 offset:4096
    global_load_dwordx4 a[180:183], v1, s[62:63] offset:1024 sc1
    v_mfma_f32_16x16x32_bf16 v[160:163], v[244:247], v[76:79], v[160:163]
    v_mfma_f32_16x16x32_bf16 v[164:167], v[248:251], v[76:79], v[164:167]
    ds_read_b128 v[200:203], v12 offset:5120
    v_mfma_f32_16x16x32_bf16 v[168:171], v[252:255], v[76:79], v[168:171]
    ds_read_b128 v[204:207], v12 offset:6144
    s_waitcnt vmcnt(10) lgkmcnt(5)
    v_mfma_f32_16x16x32_bf16 v[152:155], v[120:123], v[80:83], v[152:155]
    ds_read_b128 v[208:211], v12 offset:7168
    global_load_dwordx4 a[184:187], v1, s[62:63] offset:2048 sc1
    v_mfma_f32_16x16x32_bf16 v[156:159], v[124:127], v[80:83], v[156:159]
    v_mfma_f32_16x16x32_bf16 v[160:163], v[128:131], v[80:83], v[160:163]
    ds_read_b128 v[212:215], v12 offset:8192
    v_mfma_f32_16x16x32_bf16 v[164:167], v[132:135], v[80:83], v[164:167]
    ds_read_b128 v[216:219], v12 offset:9216
    v_mfma_f32_16x16x32_bf16 v[168:171], v[136:139], v[80:83], v[168:171]
    ds_read_b128 v[220:223], v12 offset:10240
    global_load_dwordx4 a[188:191], v1, s[62:63] offset:3072 sc1
    s_waitcnt vmcnt(11)
    v_mfma_f32_16x16x32_bf16 v[152:155], v[140:143], v[84:87], v[152:155]
    s_add_u32 s62, s24, 8192
    s_add_u32 s62, s36, s62
    s_addc_u32 s63, s37, 0
    v_mfma_f32_16x16x32_bf16 v[156:159], v[144:147], v[84:87], v[156:159]
    ds_read_b128 v[224:227], v12 offset:11264
    v_mfma_f32_16x16x32_bf16 v[160:163], v[148:151], v[84:87], v[160:163]
    ds_read_b128 v[228:231], v12 offset:12288
    v_mfma_f32_16x16x32_bf16 v[164:167], v[172:175], v[84:87], v[164:167]
    ds_read_b128 v[232:235], v12 offset:13312
    global_load_dwordx4 a[32:35], v1, s[62:63] offset:0 sc1
    v_mfma_f32_16x16x32_bf16 v[168:171], v[176:179], v[84:87], v[168:171]
    s_waitcnt vmcnt(11)
    v_mfma_f32_16x16x32_bf16 v[152:155], v[180:183], v[88:91], v[152:155]
    ds_read_b128 v[236:239], v12 offset:14336
    v_mfma_f32_16x16x32_bf16 v[156:159], v[184:187], v[88:91], v[156:159]
    ds_read_b128 v[240:243], v12 offset:15360
    s_waitcnt lgkmcnt(5)
    v_mfma_f32_16x16x32_bf16 v[160:163], v[188:191], v[88:91], v[160:163]
    ds_read_b128 v[244:247], v12 offset:16384
    global_load_dwordx4 a[36:39], v1, s[62:63] offset:1024 sc1
    v_mfma_f32_16x16x32_bf16 v[164:167], v[192:195], v[88:91], v[164:167]
    v_mfma_f32_16x16x32_bf16 v[168:171], v[196:199], v[88:91], v[168:171]
    ds_read_b128 v[248:251], v12 offset:17408
    s_waitcnt vmcnt(11)
    v_mfma_f32_16x16x32_bf16 v[152:155], v[200:203], v[92:95], v[152:155]
    ds_read_b128 v[252:255], v12 offset:18432
    v_mfma_f32_16x16x32_bf16 v[156:159], v[204:207], v[92:95], v[156:159]
    ds_read_b128 v[120:123], v12 offset:19456
    global_load_dwordx4 a[40:43], v1, s[62:63] offset:2048 sc1
    v_mfma_f32_16x16x32_bf16 v[160:163], v[208:211], v[92:95], v[160:163]
    v_mfma_f32_16x16x32_bf16 v[164:167], v[212:215], v[92:95], v[164:167]
    ds_read_b128 v[124:127], v12 offset:20480
    v_mfma_f32_16x16x32_bf16 v[168:171], v[216:219], v[92:95], v[168:171]
    ds_read_b128 v[128:131], v12 offset:21504
    s_waitcnt vmcnt(11)
    v_mfma_f32_16x16x32_bf16 v[152:155], v[220:223], v[96:99], v[152:155]
    ds_read_b128 v[132:135], v12 offset:22528
    global_load_dwordx4 a[44:47], v1, s[62:63] offset:3072 sc1
    s_waitcnt lgkmcnt(6)
    v_mfma_f32_16x16x32_bf16 v[156:159], v[224:227], v[96:99], v[156:159]
    s_add_u32 s62, s24, 28672
    s_add_u32 s62, s36, s62
    s_addc_u32 s63, s37, 0
    v_mfma_f32_16x16x32_bf16 v[160:163], v[228:231], v[96:99], v[160:163]
    ds_read_b128 v[136:139], v12 offset:23552
    v_mfma_f32_16x16x32_bf16 v[164:167], v[232:235], v[96:99], v[164:167]
    ds_read_b128 v[140:143], v12 offset:24576
    v_mfma_f32_16x16x32_bf16 v[168:171], v[236:239], v[96:99], v[168:171]
    ds_read_b128 v[144:147], v12 offset:25600
    global_load_dwordx4 a[112:115], v1, s[62:63] offset:0 sc1
    s_waitcnt vmcnt(12)
    v_mfma_f32_16x16x32_bf16 v[152:155], v[240:243], v[100:103], v[152:155]
    v_mfma_f32_16x16x32_bf16 v[156:159], v[244:247], v[100:103], v[156:159]
    ds_read_b128 v[148:151], v12 offset:26624
    s_waitcnt lgkmcnt(5)
    v_mfma_f32_16x16x32_bf16 v[160:163], v[248:251], v[100:103], v[160:163]
    ds_read_b128 v[172:175], v12 offset:27648
    v_mfma_f32_16x16x32_bf16 v[164:167], v[252:255], v[100:103], v[164:167]
    ds_read_b128 v[176:179], v12 offset:28672
    global_load_dwordx4 a[116:119], v1, s[62:63] offset:1024 sc1
    v_mfma_f32_16x16x32_bf16 v[168:171], v[120:123], v[100:103], v[168:171]
    ds_read_b128 v[180:183], v12 offset:29696
    s_waitcnt vmcnt(12)
    v_mfma_f32_16x16x32_bf16 v[152:155], v[124:127], v[104:107], v[152:155]
    ds_read_b128 v[184:187], v12 offset:30720
    v_mfma_f32_16x16x32_bf16 v[156:159], v[128:131], v[104:107], v[156:159]
    ds_read_b128 v[188:191], v12 offset:31744
    s_waitcnt lgkmcnt(6)
    v_mfma_f32_16x16x32_bf16 v[160:163], v[132:135], v[104:107], v[160:163]
    ds_read_b128 v[192:195], v12 offset:32768
    global_load_dwordx4 a[120:123], v1, s[62:63] offset:2048 sc1
    v_mfma_f32_16x16x32_bf16 v[164:167], v[136:139], v[104:107], v[164:167]
    ds_read_b128 v[196:199], v12 offset:33792
    v_mfma_f32_16x16x32_bf16 v[168:171], v[140:143], v[104:107], v[168:171]
    ds_read_b128 v[200:203], v12 offset:34816
    s_waitcnt vmcnt(12)
    v_mfma_f32_16x16x32_bf16 v[152:155], v[144:147], v[108:111], v[152:155]
    ds_read_b128 v[204:207], v12 offset:35840
    s_waitcnt lgkmcnt(7)
    v_mfma_f32_16x16x32_bf16 v[156:159], v[148:151], v[108:111], v[156:159]
    ds_read_b128 v[208:211], v12 offset:36864
    global_load_dwordx4 a[124:127], v1, s[62:63] offset:3072 sc1
    v_mfma_f32_16x16x32_bf16 v[160:163], v[172:175], v[108:111], v[160:163]
    ds_read_b128 v[212:215], v12 offset:37888
    v_mfma_f32_16x16x32_bf16 v[164:167], v[176:179], v[108:111], v[164:167]
    ds_read_b128 v[216:219], v12 offset:38912
    s_waitcnt lgkmcnt(7)
    v_mfma_f32_16x16x32_bf16 v[168:171], v[180:183], v[108:111], v[168:171]
    ds_read_b128 v[220:223], v12 offset:39936
    s_waitcnt vmcnt(12)
    v_mfma_f32_16x16x32_bf16 v[152:155], v[184:187], v[112:115], v[152:155]
    v_mfma_f32_16x16x32_bf16 v[156:159], v[188:191], v[112:115], v[156:159]
    s_waitcnt lgkmcnt(5)
    v_mfma_f32_16x16x32_bf16 v[160:163], v[192:195], v[112:115], v[160:163]
    v_mfma_f32_16x16x32_bf16 v[164:167], v[196:199], v[112:115], v[164:167]
    v_mfma_f32_16x16x32_bf16 v[168:171], v[200:203], v[112:115], v[168:171]
    s_waitcnt vmcnt(11) lgkmcnt(2)
    v_mfma_f32_16x16x32_bf16 v[152:155], v[204:207], v[116:119], v[152:155]
    v_mfma_f32_16x16x32_bf16 v[156:159], v[208:211], v[116:119], v[156:159]
    v_mfma_f32_16x16x32_bf16 v[160:163], v[212:215], v[116:119], v[160:163]
    s_waitcnt lgkmcnt(0)
    v_mfma_f32_16x16x32_bf16 v[164:167], v[216:219], v[116:119], v[164:167]
    v_mfma_f32_16x16x32_bf16 v[168:171], v[220:223], v[116:119], v[168:171]
    s_nop 2
    v_cvt_pk_bf16_f32 v18, v152, v153
    v_cvt_pk_bf16_f32 v19, v154, v155
    v_cvt_pk_bf16_f32 v20, v156, v157
    v_cvt_pk_bf16_f32 v21, v158, v159
    v_cvt_pk_bf16_f32 v22, v160, v161
    v_cvt_pk_bf16_f32 v23, v162, v163
    v_cvt_pk_bf16_f32 v24, v164, v165
    v_cvt_pk_bf16_f32 v25, v166, v167
    v_cvt_pk_bf16_f32 v26, v168, v169
    v_cvt_pk_bf16_f32 v27, v170, v171
    buffer_store_dwordx4 v[18:21], v36, s[36:39], s74 offen sc1
    buffer_store_dwordx4 v[22:25], v36, s[36:39], s74 offen offset:256 sc1
    buffer_store_dwordx2 v[26:27], v37, s[36:39], s74 offen offset:1024 sc1
    v_mov_b32 v152, 0
    v_mov_b32 v153, 0
    v_dot2_f32_bf16 v152, v18, s94, v152
    v_dot2_f32_bf16 v153, v18, v18, v153
    v_dot2_f32_bf16 v152, v19, s94, v152
    v_dot2_f32_bf16 v153, v19, v19, v153
    v_dot2_f32_bf16 v152, v20, s94, v152
    v_dot2_f32_bf16 v153, v20, v20, v153
    v_dot2_f32_bf16 v152, v21, s94, v152
    v_dot2_f32_bf16 v153, v21, v21, v153
    v_dot2_f32_bf16 v152, v22, s94, v152
    v_dot2_f32_bf16 v153, v22, v22, v153
    v_dot2_f32_bf16 v152, v23, s94, v152
    v_dot2_f32_bf16 v153, v23, v23, v153
    v_dot2_f32_bf16 v152, v24, s94, v152
    v_dot2_f32_bf16 v153, v24, v24, v153
    v_dot2_f32_bf16 v152, v25, s94, v152
    v_dot2_f32_bf16 v153, v25, v25, v153
    v_dot2_f32_bf16 v152, v26, s94, v152
    v_dot2_f32_bf16 v153, v26, v26, v153
    v_dot2_f32_bf16 v152, v27, s94, v152
    v_dot2_f32_bf16 v153, v27, v27, v153
    s_nop 2
    v_permlane32_swap_b32 v152, v153
    v_add_f32 v152, v152, v153
    v_mov_b32 v154, v152
    s_nop 1
    v_permlane16_swap_b32 v152, v154
    v_add_f32 v152, v152, v154
    buffer_store_dword v152, v35, s[36:39], s75 offen sc1
    s_mul_i32 s89, s68, 245760
    s_mul_i32 s73, s67, 61440
    s_add_u32 s89, s89, s73
    s_add_u32 s89, s89, 22020096
    s_mul_i32 s80, s67, 24576
    s_mul_i32 s74, s65, 12288
    s_mul_i32 s75, s67, 3072
    s_add_u32 s74, s74, s75
    s_add_u32 s74, s74, 29360128
    s_add_u32 s62, s24, 49152
    s_add_u32 s62, s36, s62
    s_addc_u32 s63, s37, 0
    global_load_dwordx4 a[192:195], v1, s[62:63] offset:0 sc1
    global_load_dwordx4 a[196:199], v1, s[62:63] offset:1024 sc1
    global_load_dwordx4 a[200:203], v1, s[62:63] offset:2048 sc1
    global_load_dwordx4 a[204:207], v1, s[62:63] offset:3072 sc1
    v_mov_b32 v64, 1065369472
    v_mov_b32 v65, 1065369472
    v_mov_b32 v66, 1065369472
    v_mov_b32 v67, 1065369472
    s_waitcnt vmcnt(4)
    s_barrier
    s_lshl_b32 s72, s64, 11
    s_lshl_b32 s73, s65, 7
    s_add_u32 s72, s72, s73
    s_add_u32 s72, s72, 102400
    buffer_store_dwordx2 v[8:9], v5, s[36:39], s72 offen sc1
    buffer_load_dwordx4 v[40:43], v1, s[36:39], s74 offen offset:0 sc1
    buffer_load_dwordx4 v[44:47], v1, s[36:39], s74 offen offset:1024 sc1
    buffer_load_dwordx4 v[48:51], v1, s[36:39], s74 offen offset:2048 sc1
    s_add_u32 s62, s24, 12288
    s_add_u32 s62, s36, s62
    s_addc_u32 s63, s37, 0
    global_load_dwordx4 a[48:51], v1, s[62:63] offset:0 sc1
    global_load_dwordx4 a[52:55], v1, s[62:63] offset:1024 sc1
    global_load_dwordx4 a[56:59], v1, s[62:63] offset:2048 sc1
    global_load_dwordx4 a[60:63], v1, s[62:63] offset:3072 sc1
    s_add_u32 s62, s24, 32768
    s_add_u32 s62, s36, s62
    s_addc_u32 s63, s37, 0
    global_load_dwordx4 a[128:131], v1, s[62:63] offset:0 sc1
    global_load_dwordx4 a[132:135], v1, s[62:63] offset:1024 sc1
    global_load_dwordx4 a[136:139], v1, s[62:63] offset:2048 sc1
    global_load_dwordx4 a[140:143], v1, s[62:63] offset:3072 sc1
    s_waitcnt vmcnt(10)
    v_mfma_f32_16x16x32_bf16 v[28:31], v[40:43], v[64:67], 0
    s_waitcnt vmcnt(9)
    v_mfma_f32_16x16x32_bf16 v[32:35], v[44:47], v[64:67], 0
    s_waitcnt vmcnt(8)
    v_mfma_f32_16x16x32_bf16 v[36:39], v[48:51], v[64:67], 0
    s_mul_i32 s82, s67, 5120
    s_mul_i32 s81, s64, 163840
    s_add_u32 s81, s81, s82
    s_add_u32 s81, s81, 5242880
    v_lshlrev_b32 v11, 9, v2
    v_lshl_add_u32 v11, v3, 3, v11
    s_lshl_b32 s19, s64, 13
    s_lshl_b32 s73, s67, 11
    s_add_u32 s19, s19, s73
    s_add_u32 s19, s19, 7864320
    v_add_u32 v108, 102400, v1
    v_lshrrev_b32 v111, 1, v1
    v_lshlrev_b32 v98, 3, v3
    v_add_u32 v98, 0, v98
    v_lshlrev_b32 v109, 4, v3
    v_add_u32 v109, 100352, v109
    v_mov_b32 v13, 1073741824
    v_cmp_gt_u32 vcc, 3, v2
    s_nop 1
    v_cndmask_b32 v110, v13, v1, vcc
    s_mul_i32 s91, s64, 393216
    s_mul_i32 s72, s65, 3072
    s_add_u32 s91, s91, s72
    s_mul_i32 s72, s67, 768
    s_add_u32 s91, s91, s72
    s_add_u32 s91, s91, 8388608
    s_lshl_b32 s72, s64, 3
    s_add_u32 s72, s72, s69
    s_mul_i32 s85, s72, 49152
    s_mul_i32 s72, s67, 12288
    s_add_u32 s85, s85, s72
    s_add_u32 s85, s85, 8388608
    s_lshl_b32 s84, s64, 11
    s_add_u32 s84, s84, 135168
    s_lshl_b32 s23, s64, 11
    s_add_u32 s23, s23, 102400
    buffer_load_dwordx2 v[92:93], v6, s[36:39], s23 offen sc1
    s_add_u32 s62, s24, 53248
    s_add_u32 s62, s36, s62
    s_addc_u32 s63, s37, 0
    global_load_dwordx4 a[208:211], v1, s[62:63] offset:0 sc1
    global_load_dwordx4 a[212:215], v1, s[62:63] offset:1024 sc1
    global_load_dwordx4 a[216:219], v1, s[62:63] offset:2048 sc1
    global_load_dwordx4 a[220:223], v1, s[62:63] offset:3072 sc1
    s_add_u32 s62, s24, 16384
    s_add_u32 s62, s36, s62
    s_addc_u32 s63, s37, 0
    global_load_dwordx4 a[64:67], v1, s[62:63] offset:0 sc1
    global_load_dwordx4 a[68:71], v1, s[62:63] offset:1024 sc1
    s_waitcnt vmcnt(6)
    v_cmp_ne_u64 vcc, s[70:71], v[92:93]
    s_cbranch_vccz L_pd5
    s_mov_b32 s95, 100000
L_pl5:
    buffer_load_dwordx2 v[92:93], v6, s[36:39], s23 offen sc1
    s_waitcnt vmcnt(0)
    v_cmp_ne_u64 vcc, s[70:71], v[92:93]
    s_cbranch_vccz L_pd5
    s_sub_u32 s95, s95, 1
    s_cbranch_scc0 L_pl5
L_pd5:
    s_add_u32 s34, s36, s81
    s_addc_u32 s35, s37, 0
    s_add_u32 m0, s82, 102400
    s_nop 0
    global_load_lds_dwordx4 v1, s[34:35] offset:0 sc1
    global_load_lds_dwordx4 v1, s[34:35] offset:1024 sc1
    global_load_lds_dwordx4 v1, s[34:35] offset:2048 sc1
    global_load_lds_dwordx4 v1, s[34:35] offset:3072 sc1
    s_add_u32 m0, s82, 106496
    s_nop 0
    global_load_lds_dwordx4 v17, s[34:35] offset:0 sc1
    s_add_u32 s62, s24, 16384
    s_add_u32 s62, s36, s62
    s_addc_u32 s63, s37, 0
    global_load_dwordx4 a[72:75], v1, s[62:63] offset:2048 sc1
    global_load_dwordx4 a[76:79], v1, s[62:63] offset:3072 sc1
    s_add_u32 s62, s24, 36864
    s_add_u32 s62, s36, s62
    s_addc_u32 s63, s37, 0
    global_load_dwordx4 a[144:147], v1, s[62:63] offset:0 sc1
    global_load_dwordx4 a[148:151], v1, s[62:63] offset:1024 sc1
    s_add_u32 s34, s81, 20480
    s_add_u32 s34, s36, s34
    s_addc_u32 s35, s37, 0
    s_add_u32 m0, s82, 122880
    s_nop 0
    global_load_lds_dwordx4 v1, s[34:35] offset:0 sc1
    global_load_lds_dwordx4 v1, s[34:35] offset:1024 sc1
    global_load_lds_dwordx4 v1, s[34:35] offset:2048 sc1
    global_load_lds_dwordx4 v1, s[34:35] offset:3072 sc1
    s_add_u32 m0, s82, 126976
    s_nop 0
    global_load_lds_dwordx4 v17, s[34:35] offset:0 sc1
    buffer_load_dwordx2 v[92:93], v11, s[36:39], s19 offen offset:0 sc1
    buffer_load_dwordx2 v[94:95], v11, s[36:39], s19 offen offset:128 sc1
    buffer_load_dwordx2 v[96:97], v11, s[36:39], s19 offen offset:256 sc1
    buffer_load_dwordx2 v[98:99], v11, s[36:39], s19 offen offset:384 sc1
    s_waitcnt vmcnt(13)
    s_barrier
    ds_read_b128 v[64:67], v108 offset:0
    ds_read_b128 v[68:71], v108 offset:1024
    ds_read_b128 v[72:75], v108 offset:2048
    ds_read_b128 v[76:79], v108 offset:3072
    s_waitcnt lgkmcnt(3)
    v_mfma_f32_16x16x32_bf16 v[40:43], a[0:3], v[64:67], 0
    ds_read_b128 v[80:83], v108 offset:4096
    v_mfma_f32_16x16x32_bf16 v[44:47], a[80:83], v[64:67], 0
    s_add_u32 s62, s24, 36864
    v_mfma_f32_16x16x32_bf16 v[48:51], a[160:163], v[64:67], 0
    s_add_u32 s62, s36, s62
    s_addc_u32 s63, s37, 0
    global_load_dwordx4 a[152:155], v1, s[62:63] offset:2048 sc1
    s_waitcnt lgkmcnt(3)
    v_mfma_f32_16x16x32_bf16 v[40:43], a[4:7], v[68:71], v[40:43]
    ds_read_b128 v[84:87], v108 offset:5120
    v_mfma_f32_16x16x32_bf16 v[44:47], a[84:87], v[68:71], v[44:47]
    v_mfma_f32_16x16x32_bf16 v[48:51], a[164:167], v[68:71], v[48:51]
    s_waitcnt lgkmcnt(2)
    v_mfma_f32_16x16x32_bf16 v[40:43], a[8:11], v[72:75], v[40:43]
    ds_read_b128 v[64:67], v108 offset:6144
    global_load_dwordx4 a[156:159], v1, s[62:63] offset:3072 sc1
    v_mfma_f32_16x16x32_bf16 v[44:47], a[88:91], v[72:75], v[44:47]
    v_mfma_f32_16x16x32_bf16 v[48:51], a[168:171], v[72:75], v[48:51]
    v_mfma_f32_16x16x32_bf16 v[40:43], a[12:15], v[76:79], v[40:43]
    ds_read_b128 v[68:71], v108 offset:7168
    s_add_u32 s62, s24, 57344
    v_mfma_f32_16x16x32_bf16 v[44:47], a[92:95], v[76:79], v[44:47]
    s_add_u32 s62, s36, s62
    s_addc_u32 s63, s37, 0
    global_load_dwordx4 a[224:227], v1, s[62:63] offset:0 sc1
    v_mfma_f32_16x16x32_bf16 v[48:51], a[172:175], v[76:79], v[48:51]
    s_waitcnt lgkmcnt(2)
    v_mfma_f32_16x16x32_bf16 v[40:43], a[16:19], v[80:83], v[40:43]
    ds_read_b128 v[72:75], v108 offset:8192
    v_mfma_f32_16x16x32_bf16 v[44:47], a[96:99], v[80:83], v[44:47]
    v_mfma_f32_16x16x32_bf16 v[48:51], a[176:179], v[80:83], v[48:51]
    global_load_dwordx4 a[228:231], v1, s[62:63] offset:1024 sc1
    v_mfma_f32_16x16x32_bf16 v[40:43], a[20:23], v[84:87], v[40:43]
    ds_read_b128 v[76:79], v108 offset:9216
    s_waitcnt vmcnt(6)
    v_add_f32 v92, v92, v94
    v_mfma_f32_16x16x32_bf16 v[44:47], a[100:103], v[84:87], v[44:47]
    v_add_f32 v93, v93, v95
    s_waitcnt vmcnt(4)
    v_add_f32 v96, v96, v98
    v_mfma_f32_16x16x32_bf16 v[48:51], a[180:183], v[84:87], v[48:51]
    s_waitcnt lgkmcnt(2)
    global_load_dwordx4 a[232:235], v1, s[62:63] offset:2048 sc1
    v_add_f32 v97, v97, v99
    v_mfma_f32_16x16x32_bf16 v[40:43], a[24:27], v[64:67], v[40:43]
    ds_read_b128 v[80:83], v108 offset:10240
    global_load_dwordx4 a[236:239], v1, s[62:63] offset:3072 sc1
    v_mfma_f32_16x16x32_bf16 v[44:47], a[104:107], v[64:67], v[44:47]
    s_add_u32 s32, s89, 4096
    v_add_f32 v92, v92, v96
    v_add_f32 v93, v93, v97
    v_mfma_f32_16x16x32_bf16 v[48:51], a[184:187], v[64:67], v[48:51]
    s_add_u32 s32, s36, s32
    s_addc_u32 s33, s37, 0
    v_mov_b32 v94, v92
    v_mfma_f32_16x16x32_bf16 v[40:43], a[28:31], v[68:71], v[40:43]
    ds_read_b128 v[84:87], v108 offset:11264
    v_mov_b32 v95, v93
    v_mfma_f32_16x16x32_bf16 v[44:47], a[108:111], v[68:71], v[44:47]
    v_lshrrev_b32 v11, 1, v2
    v_lshlrev_b32 v11, 8, v11
    v_mfma_f32_16x16x32_bf16 v[48:51], a[188:191], v[68:71], v[48:51]
    s_waitcnt lgkmcnt(2)
    v_permlane16_swap_b32 v92, v94
    v_mfma_f32_16x16x32_bf16 v[40:43], a[32:35], v[72:75], v[40:43]
    ds_read_b128 v[64:67], v108 offset:12288
    v_mfma_f32_16x16x32_bf16 v[44:47], a[112:115], v[72:75], v[44:47]
    v_permlane16_swap_b32 v93, v95
    v_mfma_f32_16x16x32_bf16 v[48:51], a[192:195], v[72:75], v[48:51]
    global_load_dwordx4 v[112:115], v1, s[32:33] offset:-4096 sc1
    global_load_dwordx4 v[116:119], v1, s[32:33] offset:-3072 sc1
    v_mfma_f32_16x16x32_bf16 v[40:43], a[36:39], v[76:79], v[40:43]
    ds_read_b128 v[68:71], v108 offset:13312
    v_add_f32 v92, v92, v94
    v_mfma_f32_16x16x32_bf16 v[44:47], a[116:119], v[76:79], v[44:47]
    v_add_f32 v93, v93, v95
    v_mul_f32 v92, s5, v92
    v_mfma_f32_16x16x32_bf16 v[48:51], a[196:199], v[76:79], v[48:51]
    s_waitcnt lgkmcnt(2)
    v_mul_f32 v93, s5, v93
    v_fma_f32 v93, -v92, v92, v93
    v_mfma_f32_16x16x32_bf16 v[40:43], a[40:43], v[80:83], v[40:43]
    ds_read_b128 v[72:75], v108 offset:14336
    v_max_f32 v93, 0, v93
    v_mfma_f32_16x16x32_bf16 v[44:47], a[120:123], v[80:83], v[44:47]
    v_add_f32 v99, s6, v93
    v_sub_f32 v96, 0, v92
    v_mfma_f32_16x16x32_bf16 v[48:51], a[200:203], v[80:83], v[48:51]
    v_rsq_f32 v94, v99
    v_mfma_f32_16x16x32_bf16 v[40:43], a[44:47], v[84:87], v[40:43]
    ds_read_b128 v[76:79], v108 offset:15360
    v_mfma_f32_16x16x32_bf16 v[44:47], a[124:127], v[84:87], v[44:47]
    global_load_dwordx4 v[120:123], v1, s[32:33] offset:-2048 sc1
    global_load_dwordx4 v[124:127], v1, s[32:33] offset:-1024 sc1
    v_mfma_f32_16x16x32_bf16 v[48:51], a[204:207], v[84:87], v[48:51]
    s_waitcnt lgkmcnt(2)
    v_lshl_add_u32 v11, v3, 4, v11
    v_mul_f32 v97, s7, v94
    v_mfma_f32_16x16x32_bf16 v[40:43], a[48:51], v[64:67], v[40:43]
    ds_read_b128 v[80:83], v108 offset:16384
    v_mul_f32 v95, v94, v94
    v_mfma_f32_16x16x32_bf16 v[44:47], a[128:131], v[64:67], v[44:47]
    v_mul_f32 v98, s8, v94
    v_mul_f32 v98, v98, v95
    v_mfma_f32_16x16x32_bf16 v[48:51], a[208:211], v[64:67], v[48:51]
    s_lshl_b32 s72, s67, 9
    s_add_u32 s72, s72, 100352
    v_add_u32 v11, s72, v11
    v_mfma_f32_16x16x32_bf16 v[40:43], a[52:55], v[68:71], v[40:43]
    ds_read_b128 v[84:87], v108 offset:17408
    v_mfma_f32_16x16x32_bf16 v[44:47], a[132:135], v[68:71], v[44:47]
    ds_write_b128 v11, v[96:99]
    v_mfma_f32_16x16x32_bf16 v[48:51], a[212:215], v[68:71], v[48:51]
    s_waitcnt lgkmcnt(3)
    s_waitcnt lgkmcnt(0)
    s_barrier
    v_mfma_f32_16x16x32_bf16 v[40:43], a[56:59], v[72:75], v[40:43]
    ds_read_b128 v[64:67], v108 offset:18432
    v_mfma_f32_16x16x32_bf16 v[44:47], a[136:139], v[72:75], v[44:47]
    s_add_u32 s34, s81, 40960
    v_mfma_f32_16x16x32_bf16 v[48:51], a[216:219], v[72:75], v[48:51]
    s_add_u32 s34, s36, s34
    s_addc_u32 s35, s37, 0
    s_add_u32 m0, s82, 143360
    v_mfma_f32_16x16x32_bf16 v[40:43], a[60:63], v[76:79], v[40:43]
    ds_read_b128 v[68:71], v108 offset:19456
    global_load_lds_dwordx4 v1, s[34:35] offset:0 sc1
    v_mfma_f32_16x16x32_bf16 v[44:47], a[140:143], v[76:79], v[44:47]
    v_mfma_f32_16x16x32_bf16 v[48:51], a[220:223], v[76:79], v[48:51]
    v_mfma_f32_16x16x32_bf16 v[40:43], a[64:67], v[80:83], v[40:43]
    ds_read_b128 v[72:75], v108 offset:20480
    v_mfma_f32_16x16x32_bf16 v[44:47], a[144:147], v[80:83], v[44:47]
    global_load_lds_dwordx4 v1, s[34:35] offset:1024 sc1
    s_waitcnt vmcnt(9)
    v_mfma_f32_16x16x32_bf16 v[48:51], a[224:227], v[80:83], v[48:51]
    v_mfma_f32_16x16x32_bf16 v[40:43], a[68:71], v[84:87], v[40:43]
    ds_read_b128 v[76:79], v108 offset:21504
    v_mfma_f32_16x16x32_bf16 v[44:47], a[148:151], v[84:87], v[44:47]
    global_load_lds_dwordx4 v1, s[34:35] offset:2048 sc1
    s_waitcnt vmcnt(9)
    v_mfma_f32_16x16x32_bf16 v[48:51], a[228:231], v[84:87], v[48:51]
    s_waitcnt lgkmcnt(2)
    v_mfma_f32_16x16x32_bf16 v[40:43], a[72:75], v[64:67], v[40:43]
    ds_read_b128 v[80:83], v108 offset:22528
    v_mfma_f32_16x16x32_bf16 v[44:47], a[152:155], v[64:67], v[44:47]
    global_load_lds_dwordx4 v1, s[34:35] offset:3072 sc1
    s_waitcnt vmcnt(9)
    v_mfma_f32_16x16x32_bf16 v[48:51], a[232:235], v[64:67], v[48:51]
    v_mfma_f32_16x16x32_bf16 v[40:43], a[76:79], v[68:71], v[40:43]
    ds_read_b128 v[84:87], v108 offset:23552
    v_mfma_f32_16x16x32_bf16 v[44:47], a[156:159], v[68:71], v[44:47]
    s_add_u32 m0, s82, 147456
    s_waitcnt vmcnt(8)
    v_mfma_f32_16x16x32_bf16 v[48:51], a[236:239], v[68:71], v[48:51]
    s_waitcnt lgkmcnt(2)
    global_load_lds_dwordx4 v17, s[34:35] offset:0 sc1
    ds_read_b128 v[88:91], v109 offset:0
    v_mfma_f32_16x16x32_bf16 v[52:55], a[0:3], v[72:75], 0
    ds_read_b128 v[64:67], v108 offset:24576
    s_add_u32 s32, s89, 4096
    v_mfma_f32_16x16x32_bf16 v[56:59], a[80:83], v[72:75], 0
    s_add_u32 s32, s36, s32
    s_addc_u32 s33, s37, 0
    global_load_dwordx4 v[128:131], v1, s[32:33] offset:0 sc1
    v_mfma_f32_16x16x32_bf16 v[60:63], a[160:163], v[72:75], 0
    s_waitcnt lgkmcnt(1)
    v_fmac_f32 v40, v88, v28
    v_fmac_f32 v42, v88, v30
    v_mfma_f32_16x16x32_bf16 v[52:55], a[4:7], v[76:79], v[52:55]
    ds_read_b128 v[68:71], v108 offset:25600
    v_mul_f32 v96, v40, v40
    v_mfma_f32_16x16x32_bf16 v[56:59], a[84:87], v[76:79], v[56:59]
    global_load_dwordx4 v[132:135], v1, s[32:33] offset:1024 sc1
    v_mul_f32 v42, v40, v42
    v_mfma_f32_16x16x32_bf16 v[60:63], a[164:167], v[76:79], v[60:63]
    v_fma_f32 v96, v96, v90, v89
    v_mul_f32 v96, v96, v40
    v_mfma_f32_16x16x32_bf16 v[52:55], a[8:11], v[80:83], v[52:55]
    ds_read_b128 v[72:75], v108 offset:26624
    v_exp_f32 v96, v96
    v_mfma_f32_16x16x32_bf16 v[56:59], a[88:91], v[80:83], v[56:59]
    global_load_dwordx4 v[136:139], v1, s[32:33] offset:2048 sc1
    v_fmac_f32 v41, v88, v29
    v_mfma_f32_16x16x32_bf16 v[60:63], a[168:171], v[80:83], v[60:63]
    v_fmac_f32 v43, v88, v31
    v_mul_f32 v97, v41, v41
    v_mfma_f32_16x16x32_bf16 v[52:55], a[12:15], v[84:87], v[52:55]
    ds_read_b128 v[76:79], v108 offset:27648
    v_mul_f32 v43, v41, v43
    v_mfma_f32_16x16x32_bf16 v[56:59], a[92:95], v[84:87], v[56:59]
    v_fma_f32 v97, v97, v90, v89
    v_mul_f32 v97, v97, v41
    v_mfma_f32_16x16x32_bf16 v[60:63], a[172:175], v[84:87], v[60:63]
    s_waitcnt lgkmcnt(2)
    v_exp_f32 v97, v97
    v_mfma_f32_16x16x32_bf16 v[52:55], a[16:19], v[64:67], v[52:55]
    ds_read_b128 v[80:83], v108 offset:28672
    v_fma_f32 v96, v96, v91, v91
    v_mfma_f32_16x16x32_bf16 v[56:59], a[96:99], v[64:67], v[56:59]
    v_rcp_f32 v96, v96
    v_mfma_f32_16x16x32_bf16 v[60:63], a[176:179], v[64:67], v[60:63]
    v_fma_f32 v97, v97, v91, v91
    v_rcp_f32 v97, v97
    v_mfma_f32_16x16x32_bf16 v[52:55], a[20:23], v[68:71], v[52:55]
    ds_read_b128 v[84:87], v108 offset:29696
    v_mul_f32 v42, v42, v96
    v_mfma_f32_16x16x32_bf16 v[56:59], a[100:103], v[68:71], v[56:59]
    v_mul_f32 v43, v43, v97
    v_cvt_pk_bf16_f32 v92, v42, v43
    v_mfma_f32_16x16x32_bf16 v[60:63], a[180:183], v[68:71], v[60:63]
    s_waitcnt lgkmcnt(2)
    v_permlane16_swap_b32 v92, v95
    v_mfma_f32_16x16x32_bf16 v[52:55], a[24:27], v[72:75], v[52:55]
    ds_read_b128 v[64:67], v108 offset:30720
    global_load_dwordx4 v[140:143], v1, s[32:33] offset:3072 sc1
    v_mfma_f32_16x16x32_bf16 v[56:59], a[104:107], v[72:75], v[56:59]
    s_add_u32 s32, s89, 12288
    v_fmac_f32 v44, v88, v32
    v_fmac_f32 v46, v88, v34
    v_mfma_f32_16x16x32_bf16 v[60:63], a[184:187], v[72:75], v[60:63]
    s_add_u32 s32, s36, s32
    s_addc_u32 s33, s37, 0
    global_load_dwordx4 v[144:147], v1, s[32:33] offset:-4096 sc1
    v_mfma_f32_16x16x32_bf16 v[52:55], a[28:31], v[76:79], v[52:55]
    ds_read_b128 v[68:71], v108 offset:31744
    v_mul_f32 v96, v44, v44
    v_mfma_f32_16x16x32_bf16 v[56:59], a[108:111], v[76:79], v[56:59]
    global_load_dwordx4 v[148:151], v1, s[32:33] offset:-3072 sc1
    v_mul_f32 v46, v44, v46
    v_mfma_f32_16x16x32_bf16 v[60:63], a[188:191], v[76:79], v[60:63]
    s_waitcnt lgkmcnt(2)
    v_fma_f32 v96, v96, v90, v89
    v_mul_f32 v96, v96, v44
    v_mfma_f32_16x16x32_bf16 v[52:55], a[32:35], v[80:83], v[52:55]
    ds_read_b128 v[72:75], v108 offset:32768
    v_exp_f32 v96, v96
    v_mfma_f32_16x16x32_bf16 v[56:59], a[112:115], v[80:83], v[56:59]
    v_fmac_f32 v45, v88, v33
    v_fmac_f32 v47, v88, v35
    v_mfma_f32_16x16x32_bf16 v[60:63], a[192:195], v[80:83], v[60:63]
    v_mul_f32 v97, v45, v45
    v_mul_f32 v47, v45, v47
    v_mfma_f32_16x16x32_bf16 v[52:55], a[36:39], v[84:87], v[52:55]
    ds_read_b128 v[76:79], v108 offset:33792
    global_load_dwordx4 v[152:155], v1, s[32:33] offset:-2048 sc1
    v_mfma_f32_16x16x32_bf16 v[56:59], a[116:119], v[84:87], v[56:59]
    v_fma_f32 v97, v97, v90, v89
    v_mul_f32 v97, v97, v45
    v_mfma_f32_16x16x32_bf16 v[60:63], a[196:199], v[84:87], v[60:63]
    s_waitcnt lgkmcnt(2)
    v_exp_f32 v97, v97
    v_mfma_f32_16x16x32_bf16 v[52:55], a[40:43], v[64:67], v[52:55]
    ds_read_b128 v[80:83], v108 offset:34816
    v_fma_f32 v96, v96, v91, v91
    v_mfma_f32_16x16x32_bf16 v[56:59], a[120:123], v[64:67], v[56:59]
    v_rcp_f32 v96, v96
    v_mfma_f32_16x16x32_bf16 v[60:63], a[200:203], v[64:67], v[60:63]
    v_fma_f32 v97, v97, v91, v91
    v_rcp_f32 v97, v97
    v_mfma_f32_16x16x32_bf16 v[52:55], a[44:47], v[68:71], v[52:55]
    ds_read_b128 v[84:87], v108 offset:35840
    v_mul_f32 v46, v46, v96
    v_mfma_f32_16x16x32_bf16 v[56:59], a[124:127], v[68:71], v[56:59]
    v_mul_f32 v47, v47, v97
    v_cvt_pk_bf16_f32 v93, v46, v47
    v_mfma_f32_16x16x32_bf16 v[60:63], a[204:207], v[68:71], v[60:63]
    s_waitcnt lgkmcnt(2)
    v_permlane32_swap_b32 v93, v92
    v_mfma_f32_16x16x32_bf16 v[52:55], a[48:51], v[72:75], v[52:55]
    ds_read_b128 v[64:67], v108 offset:36864
    global_load_dwordx4 v[156:159], v1, s[32:33] offset:-1024 sc1
    v_mfma_f32_16x16x32_bf16 v[56:59], a[128:131], v[72:75], v[56:59]
    v_fmac_f32 v48, v88, v36
    v_fmac_f32 v50, v88, v38
    v_mfma_f32_16x16x32_bf16 v[60:63], a[208:211], v[72:75], v[60:63]
    v_mul_f32 v96, v48, v48
    v_mul_f32 v50, v48, v50
    v_mfma_f32_16x16x32_bf16 v[52:55], a[52:55], v[76:79], v[52:55]
    ds_read_b128 v[68:71], v108 offset:37888
    v_fma_f32 v96, v96, v90, v89
    v_mfma_f32_16x16x32_bf16 v[56:59], a[132:135], v[76:79], v[56:59]
    v_mul_f32 v96, v96, v48
    v_exp_f32 v96, v96
    v_mfma_f32_16x16x32_bf16 v[60:63], a[212:215], v[76:79], v[60:63]
    s_waitcnt lgkmcnt(2)
    s_waitcnt vmcnt(8)
    s_barrier
    v_mfma_f32_16x16x32_bf16 v[52:55], a[56:59], v[80:83], v[52:55]
    ds_read_b128 v[72:75], v108 offset:38912
    v_fmac_f32 v49, v88, v37
    v_mfma_f32_16x16x32_bf16 v[56:59], a[136:139], v[80:83], v[56:59]
    s_add_u32 s34, s81, 61440
    s_add_u32 s34, s36, s34
    s_addc_u32 s35, s37, 0
    v_mfma_f32_16x16x32_bf16 v[60:63], a[216:219], v[80:83], v[60:63]
    s_add_u32 m0, s82, 102400
    v_fmac_f32 v51, v88, v39
    v_mul_f32 v97, v49, v49
    v_mfma_f32_16x16x32_bf16 v[52:55], a[60:63], v[84:87], v[52:55]
    ds_read_b128 v[76:79], v108 offset:39936
    global_load_lds_dwordx4 v1, s[34:35] offset:0 sc1
    v_mfma_f32_16x16x32_bf16 v[56:59], a[140:143], v[84:87], v[56:59]
    global_load_lds_dwordx4 v1, s[34:35] offset:1024 sc1
    v_mul_f32 v51, v49, v51
    v_mfma_f32_16x16x32_bf16 v[60:63], a[220:223], v[84:87], v[60:63]
    s_waitcnt lgkmcnt(2)
    v_fma_f32 v97, v97, v90, v89
    v_mul_f32 v97, v97, v49
    v_mfma_f32_16x16x32_bf16 v[52:55], a[64:67], v[64:67], v[52:55]
    ds_read_b128 v[80:83], v108 offset:40960
    global_load_lds_dwordx4 v1, s[34:35] offset:2048 sc1
    v_mfma_f32_16x16x32_bf16 v[56:59], a[144:147], v[64:67], v[56:59]
    v_exp_f32 v97, v97
    v_mfma_f32_16x16x32_bf16 v[60:63], a[224:227], v[64:67], v[60:63]
    v_fma_f32 v96, v96, v91, v91
    v_rcp_f32 v96, v96
    v_mfma_f32_16x16x32_bf16 v[52:55], a[68:71], v[68:71], v[52:55]
    ds_read_b128 v[84:87], v108 offset:41984
    v_fma_f32 v97, v97, v91, v91
    v_mfma_f32_16x16x32_bf16 v[56:59], a[148:151], v[68:71], v[56:59]
    v_rcp_f32 v97, v97
    v_mfma_f32_16x16x32_bf16 v[60:63], a[228:231], v[68:71], v[60:63]
    s_waitcnt lgkmcnt(2)
    v_mul_f32 v50, v50, v96
    v_mul_f32 v51, v51, v97
    v_cvt_pk_bf16_f32 v94, v50, v51
    v_mfma_f32_16x16x32_bf16 v[52:55], a[72:75], v[72:75], v[52:55]
    ds_read_b128 v[64:67], v108 offset:43008
    s_add_u32 s21, s91, 0
    v_permlane32_swap_b32 v94, v95
    v_mfma_f32_16x16x32_bf16 v[56:59], a[152:155], v[72:75], v[56:59]
    global_load_lds_dwordx4 v1, s[34:35] offset:3072 sc1
    buffer_store_dwordx4 v[92:95], v110, s[36:39], s21 offen sc1
    v_mfma_f32_16x16x32_bf16 v[60:63], a[232:235], v[72:75], v[60:63]
    v_mfma_f32_16x16x32_bf16 v[52:55], a[76:79], v[76:79], v[52:55]
    ds_read_b128 v[68:71], v108 offset:44032
    v_mfma_f32_16x16x32_bf16 v[56:59], a[156:159], v[76:79], v[56:59]
    s_add_u32 m0, s82, 106496
    v_mfma_f32_16x16x32_bf16 v[60:63], a[236:239], v[76:79], v[60:63]
    s_waitcnt lgkmcnt(2)
    global_load_lds_dwordx4 v17, s[34:35] offset:0 sc1
    ds_read_b128 v[88:91], v109 offset:256
    v_mfma_f32_16x16x32_bf16 v[40:43], a[0:3], v[80:83], 0
    ds_read_b128 v[72:75], v108 offset:45056
    s_add_u32 s32, s89, 12288
    v_mfma_f32_16x16x32_bf16 v[44:47], a[80:83], v[80:83], 0
    s_add_u32 s32, s36, s32
    s_addc_u32 s33, s37, 0
    global_load_dwordx4 v[160:163], v1, s[32:33] offset:0 sc1
    v_mfma_f32_16x16x32_bf16 v[48:51], a[160:163], v[80:83], 0
    s_waitcnt lgkmcnt(1)
    v_fmac_f32 v52, v88, v28
    v_fmac_f32 v54, v88, v30
    v_mfma_f32_16x16x32_bf16 v[40:43], a[4:7], v[84:87], v[40:43]
    ds_read_b128 v[76:79], v108 offset:46080
    v_mul_f32 v96, v52, v52
    v_mfma_f32_16x16x32_bf16 v[44:47], a[84:87], v[84:87], v[44:47]
    global_load_dwordx4 v[164:167], v1, s[32:33] offset:1024 sc1
    v_mul_f32 v54, v52, v54
    v_mfma_f32_16x16x32_bf16 v[48:51], a[164:167], v[84:87], v[48:51]
    v_fma_f32 v96, v96, v90, v89
    v_mul_f32 v96, v96, v52
    v_mfma_f32_16x16x32_bf16 v[40:43], a[8:11], v[64:67], v[40:43]
    ds_read_b128 v[80:83], v108 offset:47104
    v_exp_f32 v96, v96
    v_mfma_f32_16x16x32_bf16 v[44:47], a[88:91], v[64:67], v[44:47]
    global_load_dwordx4 v[168:171], v1, s[32:33] offset:2048 sc1
    v_fmac_f32 v53, v88, v29
    v_mfma_f32_16x16x32_bf16 v[48:51], a[168:171], v[64:67], v[48:51]
    v_fmac_f32 v55, v88, v31
    v_mul_f32 v97, v53, v53
    v_mfma_f32_16x16x32_bf16 v[40:43], a[12:15], v[68:71], v[40:43]
    ds_read_b128 v[84:87], v108 offset:48128
    v_mul_f32 v55, v53, v55
    v_mfma_f32_16x16x32_bf16 v[44:47], a[92:95], v[68:71], v[44:47]
    v_fma_f32 v97, v97, v90, v89
    v_mul_f32 v97, v97, v53
    v_mfma_f32_16x16x32_bf16 v[48:51], a[172:175], v[68:71], v[48:51]
    s_waitcnt lgkmcnt(2)
    v_exp_f32 v97, v97
    v_mfma_f32_16x16x32_bf16 v[40:43], a[16:19], v[72:75], v[40:43]
    ds_read_b128 v[64:67], v108 offset:49152
    v_fma_f32 v96, v96, v91, v91
    v_mfma_f32_16x16x32_bf16 v[44:47], a[96:99], v[72:75], v[44:47]
    v_rcp_f32 v96, v96
    v_mfma_f32_16x16x32_bf16 v[48:51], a[176:179], v[72:75], v[48:51]
    v_fma_f32 v97, v97, v91, v91
    v_rcp_f32 v97, v97
    v_mfma_f32_16x16x32_bf16 v[40:43], a[20:23], v[76:79], v[40:43]
    ds_read_b128 v[68:71], v108 offset:50176
    v_mul_f32 v54, v54, v96
    v_mfma_f32_16x16x32_bf16 v[44:47], a[100:103], v[76:79], v[44:47]
    v_mul_f32 v55, v55, v97
    v_cvt_pk_bf16_f32 v92, v54, v55
    v_mfma_f32_16x16x32_bf16 v[48:51], a[180:183], v[76:79], v[48:51]
    s_waitcnt lgkmcnt(2)
    v_permlane16_swap_b32 v92, v95
    v_mfma_f32_16x16x32_bf16 v[40:43], a[24:27], v[80:83], v[40:43]
    ds_read_b128 v[72:75], v108 offset:51200
    global_load_dwordx4 v[172:175], v1, s[32:33] offset:3072 sc1
    v_mfma_f32_16x16x32_bf16 v[44:47], a[104:107], v[80:83], v[44:47]
    s_add_u32 s32, s89, 20480
    v_fmac_f32 v56, v88, v32
    v_fmac_f32 v58, v88, v34
    v_mfma_f32_16x16x32_bf16 v[48:51], a[184:187], v[80:83], v[48:51]
    s_add_u32 s32, s36, s32
    s_addc_u32 s33, s37, 0
    global_load_dwordx4 v[176:179], v1, s[32:33] offset:-4096 sc1
    v_mfma_f32_16x16x32_bf16 v[40:43], a[28:31], v[84:87], v[40:43]
    ds_read_b128 v[76:79], v108 offset:52224
    v_mul_f32 v96, v56, v56
    v_mfma_f32_16x16x32_bf16 v[44:47], a[108:111], v[84:87], v[44:47]
    global_load_dwordx4 v[180:183], v1, s[32:33] offset:-3072 sc1
    v_mul_f32 v58, v56, v58
    v_mfma_f32_16x16x32_bf16 v[48:51], a[188:191], v[84:87], v[48:51]
    s_waitcnt lgkmcnt(2)
    v_fma_f32 v96, v96, v90, v89
    v_mul_f32 v96, v96, v56
    v_mfma_f32_16x16x32_bf16 v[40:43], a[32:35], v[64:67], v[40:43]
    ds_read_b128 v[80:83], v108 offset:53248
    v_exp_f32 v96, v96
    v_mfma_f32_16x16x32_bf16 v[44:47], a[112:115], v[64:67], v[44:47]
    v_fmac_f32 v57, v88, v33
    v_fmac_f32 v59, v88, v35
    v_mfma_f32_16x16x32_bf16 v[48:51], a[192:195], v[64:67], v[48:51]
    v_mul_f32 v97, v57, v57
    v_mul_f32 v59, v57, v59
    v_mfma_f32_16x16x32_bf16 v[40:43], a[36:39], v[68:71], v[40:43]
    ds_read_b128 v[84:87], v108 offset:54272
    global_load_dwordx4 v[184:187], v1, s[32:33] offset:-2048 sc1
    v_mfma_f32_16x16x32_bf16 v[44:47], a[116:119], v[68:71], v[44:47]
    v_fma_f32 v97, v97, v90, v89
    v_mul_f32 v97, v97, v57
    v_mfma_f32_16x16x32_bf16 v[48:51], a[196:199], v[68:71], v[48:51]
    s_waitcnt lgkmcnt(2)
    v_exp_f32 v97, v97
    v_mfma_f32_16x16x32_bf16 v[40:43], a[40:43], v[72:75], v[40:43]
    ds_read_b128 v[64:67], v108 offset:55296
    v_fma_f32 v96, v96, v91, v91
    v_mfma_f32_16x16x32_bf16 v[44:47], a[120:123], v[72:75], v[44:47]
    v_rcp_f32 v96, v96
    v_mfma_f32_16x16x32_bf16 v[48:51], a[200:203], v[72:75], v[48:51]
    v_fma_f32 v97, v97, v91, v91
    v_rcp_f32 v97, v97
    v_mfma_f32_16x16x32_bf16 v[40:43], a[44:47], v[76:79], v[40:43]
    ds_read_b128 v[68:71], v108 offset:56320
    v_mul_f32 v58, v58, v96
    v_mfma_f32_16x16x32_bf16 v[44:47], a[124:127], v[76:79], v[44:47]
    v_mul_f32 v59, v59, v97
    v_cvt_pk_bf16_f32 v93, v58, v59
    v_mfma_f32_16x16x32_bf16 v[48:51], a[204:207], v[76:79], v[48:51]
    s_waitcnt lgkmcnt(2)
    v_permlane32_swap_b32 v93, v92
    v_mfma_f32_16x16x32_bf16 v[40:43], a[48:51], v[80:83], v[40:43]
    ds_read_b128 v[72:75], v108 offset:57344
    global_load_dwordx4 v[188:191], v1, s[32:33] offset:-1024 sc1
    v_mfma_f32_16x16x32_bf16 v[44:47], a[128:131], v[80:83], v[44:47]
    v_fmac_f32 v60, v88, v36
    v_fmac_f32 v62, v88, v38
    v_mfma_f32_16x16x32_bf16 v[48:51], a[208:211], v[80:83], v[48:51]
    v_mul_f32 v96, v60, v60
    v_mul_f32 v62, v60, v62
    v_mfma_f32_16x16x32_bf16 v[40:43], a[52:55], v[84:87], v[40:43]
    ds_read_b128 v[76:79], v108 offset:58368
    v_fma_f32 v96, v96, v90, v89
    v_mfma_f32_16x16x32_bf16 v[44:47], a[132:135], v[84:87], v[44:47]
    v_mul_f32 v96, v96, v60
    v_exp_f32 v96, v96
    v_mfma_f32_16x16x32_bf16 v[48:51], a[212:215], v[84:87], v[48:51]
    s_waitcnt lgkmcnt(2)
    s_waitcnt vmcnt(8)
    s_barrier
    v_mfma_f32_16x16x32_bf16 v[40:43], a[56:59], v[64:67], v[40:43]
    ds_read_b128 v[80:83], v108 offset:59392
    v_fmac_f32 v61, v88, v37
    v_mfma_f32_16x16x32_bf16 v[44:47], a[136:139], v[64:67], v[44:47]
    s_add_u32 s34, s81, 81920
    s_add_u32 s34, s36, s34
    s_addc_u32 s35, s37, 0
    v_mfma_f32_16x16x32_bf16 v[48:51], a[216:219], v[64:67], v[48:51]
    s_add_u32 m0, s82, 122880
    v_fmac_f32 v63, v88, v39
    v_mul_f32 v97, v61, v61
    v_mfma_f32_16x16x32_bf16 v[40:43], a[60:63], v[68:71], v[40:43]
    ds_read_b128 v[84:87], v108 offset:60416
    global_load_lds_dwordx4 v1, s[34:35] offset:0 sc1
    v_mfma_f32_16x16x32_bf16 v[44:47], a[140:143], v[68:71], v[44:47]
    global_load_lds_dwordx4 v1, s[34:35] offset:1024 sc1
    v_mul_f32 v63, v61, v63
    v_mfma_f32_16x16x32_bf16 v[48:51], a[220:223], v[68:71], v[48:51]
    s_waitcnt lgkmcnt(2)
    v_fma_f32 v97, v97, v90, v89
    v_mul_f32 v97, v97, v61
    v_mfma_f32_16x16x32_bf16 v[40:43], a[64:67], v[72:75], v[40:43]
    ds_read_b128 v[64:67], v108 offset:0
    global_load_lds_dwordx4 v1, s[34:35] offset:2048 sc1
    v_mfma_f32_16x16x32_bf16 v[44:47], a[144:147], v[72:75], v[44:47]
    v_exp_f32 v97, v97
    v_mfma_f32_16x16x32_bf16 v[48:51], a[224:227], v[72:75], v[48:51]
    v_fma_f32 v96, v96, v91, v91
    v_rcp_f32 v96, v96
    v_mfma_f32_16x16x32_bf16 v[40:43], a[68:71], v[76:79], v[40:43]
    ds_read_b128 v[68:71], v108 offset:1024
    v_fma_f32 v97, v97, v91, v91
    v_mfma_f32_16x16x32_bf16 v[44:47], a[148:151], v[76:79], v[44:47]
    v_rcp_f32 v97, v97
    v_mfma_f32_16x16x32_bf16 v[48:51], a[228:231], v[76:79], v[48:51]
    s_waitcnt lgkmcnt(2)
    v_mul_f32 v62, v62, v96
    v_mul_f32 v63, v63, v97
    v_cvt_pk_bf16_f32 v94, v62, v63
    v_mfma_f32_16x16x32_bf16 v[40:43], a[72:75], v[80:83], v[40:43]
    ds_read_b128 v[72:75], v108 offset:2048
    s_add_u32 s21, s91, 49152
    v_permlane32_swap_b32 v94, v95
    v_mfma_f32_16x16x32_bf16 v[44:47], a[152:155], v[80:83], v[44:47]
    global_load_lds_dwordx4 v1, s[34:35] offset:3072 sc1
    buffer_store_dwordx4 v[92:95], v110, s[36:39], s21 offen sc1
    v_mfma_f32_16x16x32_bf16 v[48:51], a[232:235], v[80:83], v[48:51]
    v_mfma_f32_16x16x32_bf16 v[40:43], a[76:79], v[84:87], v[40:43]
    ds_read_b128 v[76:79], v108 offset:3072
    v_mfma_f32_16x16x32_bf16 v[44:47], a[156:159], v[84:87], v[44:47]
    s_add_u32 m0, s82, 126976
    v_mfma_f32_16x16x32_bf16 v[48:51], a[236:239], v[84:87], v[48:51]
    s_waitcnt lgkmcnt(2)
    global_load_lds_dwordx4 v17, s[34:35] offset:0 sc1
    ds_read_b128 v[88:91], v109 offset:512
    v_mfma_f32_16x16x32_bf16 v[52:55], a[0:3], v[64:67], 0
    ds_read_b128 v[80:83], v108 offset:4096
    s_add_u32 s32, s89, 20480
    v_mfma_f32_16x16x32_bf16 v[56:59], a[80:83], v[64:67], 0
    s_add_u32 s32, s36, s32
    s_addc_u32 s33, s37, 0
    global_load_dwordx4 v[192:195], v1, s[32:33] offset:0 sc1
    v_mfma_f32_16x16x32_bf16 v[60:63], a[160:163], v[64:67], 0
    s_waitcnt lgkmcnt(1)
    v_fmac_f32 v40, v88, v28
    v_fmac_f32 v42, v88, v30
    v_mfma_f32_16x16x32_bf16 v[52:55], a[4:7], v[68:71], v[52:55]
    ds_read_b128 v[84:87], v108 offset:5120
    v_mul_f32 v96, v40, v40
    v_mfma_f32_16x16x32_bf16 v[56:59], a[84:87], v[68:71], v[56:59]
    global_load_dwordx4 v[196:199], v1, s[32:33] offset:1024 sc1
    v_mul_f32 v42, v40, v42
    v_mfma_f32_16x16x32_bf16 v[60:63], a[164:167], v[68:71], v[60:63]
    v_fma_f32 v96, v96, v90, v89
    v_mul_f32 v96, v96, v40
    v_mfma_f32_16x16x32_bf16 v[52:55], a[8:11], v[72:75], v[52:55]
    ds_read_b128 v[64:67], v108 offset:6144
    v_exp_f32 v96, v96
    v_mfma_f32_16x16x32_bf16 v[56:59], a[88:91], v[72:75], v[56:59]
    global_load_dwordx4 v[200:203], v1, s[32:33] offset:2048 sc1
    v_fmac_f32 v41, v88, v29
    v_mfma_f32_16x16x32_bf16 v[60:63], a[168:171], v[72:75], v[60:63]
    v_fmac_f32 v43, v88, v31
    v_mul_f32 v97, v41, v41
    v_mfma_f32_16x16x32_bf16 v[52:55], a[12:15], v[76:79], v[52:55]
    ds_read_b128 v[68:71], v108 offset:7168
    v_mul_f32 v43, v41, v43
    v_mfma_f32_16x16x32_bf16 v[56:59], a[92:95], v[76:79], v[56:59]
    v_fma_f32 v97, v97, v90, v89
    v_mul_f32 v97, v97, v41
    v_mfma_f32_16x16x32_bf16 v[60:63], a[172:175], v[76:79], v[60:63]
    s_waitcnt lgkmcnt(2)
    v_exp_f32 v97, v97
    v_mfma_f32_16x16x32_bf16 v[52:55], a[16:19], v[80:83], v[52:55]
    ds_read_b128 v[72:75], v108 offset:8192
    v_fma_f32 v96, v96, v91, v91
    v_mfma_f32_16x16x32_bf16 v[56:59], a[96:99], v[80:83], v[56:59]
    v_rcp_f32 v96, v96
    v_mfma_f32_16x16x32_bf16 v[60:63], a[176:179], v[80:83], v[60:63]
    v_fma_f32 v97, v97, v91, v91
    v_rcp_f32 v97, v97
    v_mfma_f32_16x16x32_bf16 v[52:55], a[20:23], v[84:87], v[52:55]
    ds_read_b128 v[76:79], v108 offset:9216
    v_mul_f32 v42, v42, v96
    v_mfma_f32_16x16x32_bf16 v[56:59], a[100:103], v[84:87], v[56:59]
    v_mul_f32 v43, v43, v97
    v_cvt_pk_bf16_f32 v92, v42, v43
    v_mfma_f32_16x16x32_bf16 v[60:63], a[180:183], v[84:87], v[60:63]
    s_waitcnt lgkmcnt(2)
    v_permlane16_swap_b32 v92, v95
    v_mfma_f32_16x16x32_bf16 v[52:55], a[24:27], v[64:67], v[52:55]
    ds_read_b128 v[80:83], v108 offset:10240
    global_load_dwordx4 v[204:207], v1, s[32:33] offset:3072 sc1
    v_mfma_f32_16x16x32_bf16 v[56:59], a[104:107], v[64:67], v[56:59]
    s_add_u32 s32, s89, 28672
    v_fmac_f32 v44, v88, v32
    v_fmac_f32 v46, v88, v34
    v_mfma_f32_16x16x32_bf16 v[60:63], a[184:187], v[64:67], v[60:63]
    s_add_u32 s32, s36, s32
    s_addc_u32 s33, s37, 0
    global_load_dwordx4 v[208:211], v1, s[32:33] offset:-4096 sc1
    v_mfma_f32_16x16x32_bf16 v[52:55], a[28:31], v[68:71], v[52:55]
    ds_read_b128 v[84:87], v108 offset:11264
    v_mul_f32 v96, v44, v44
    v_mfma_f32_16x16x32_bf16 v[56:59], a[108:111], v[68:71], v[56:59]
    global_load_dwordx4 v[212:215], v1, s[32:33] offset:-3072 sc1
    v_mul_f32 v46, v44, v46
    v_mfma_f32_16x16x32_bf16 v[60:63], a[188:191], v[68:71], v[60:63]
    s_waitcnt lgkmcnt(2)
    v_fma_f32 v96, v96, v90, v89
    v_mul_f32 v96, v96, v44
    v_mfma_f32_16x16x32_bf16 v[52:55], a[32:35], v[72:75], v[52:55]
    ds_read_b128 v[64:67], v108 offset:12288
    v_exp_f32 v96, v96
    v_mfma_f32_16x16x32_bf16 v[56:59], a[112:115], v[72:75], v[56:59]
    v_fmac_f32 v45, v88, v33
    v_fmac_f32 v47, v88, v35
    v_mfma_f32_16x16x32_bf16 v[60:63], a[192:195], v[72:75], v[60:63]
    v_mul_f32 v97, v45, v45
    v_mul_f32 v47, v45, v47
    v_mfma_f32_16x16x32_bf16 v[52:55], a[36:39], v[76:79], v[52:55]
    ds_read_b128 v[68:71], v108 offset:13312
    global_load_dwordx4 v[216:219], v1, s[32:33] offset:-2048 sc1
    v_mfma_f32_16x16x32_bf16 v[56:59], a[116:119], v[76:79], v[56:59]
    v_fma_f32 v97, v97, v90, v89
    v_mul_f32 v97, v97, v45
    v_mfma_f32_16x16x32_bf16 v[60:63], a[196:199], v[76:79], v[60:63]
    s_waitcnt lgkmcnt(2)
    v_exp_f32 v97, v97
    v_mfma_f32_16x16x32_bf16 v[52:55], a[40:43], v[80:83], v[52:55]
    ds_read_b128 v[72:75], v108 offset:14336
    v_fma_f32 v96, v96, v91, v91
    v_mfma_f32_16x16x32_bf16 v[56:59], a[120:123], v[80:83], v[56:59]
    v_rcp_f32 v96, v96
    v_mfma_f32_16x16x32_bf16 v[60:63], a[200:203], v[80:83], v[60:63]
    v_fma_f32 v97, v97, v91, v91
    v_rcp_f32 v97, v97
    v_mfma_f32_16x16x32_bf16 v[52:55], a[44:47], v[84:87], v[52:55]
    ds_read_b128 v[76:79], v108 offset:15360
    v_mul_f32 v46, v46, v96
    v_mfma_f32_16x16x32_bf16 v[56:59], a[124:127], v[84:87], v[56:59]
    v_mul_f32 v47, v47, v97
    v_cvt_pk_bf16_f32 v93, v46, v47
    v_mfma_f32_16x16x32_bf16 v[60:63], a[204:207], v[84:87], v[60:63]
    s_waitcnt lgkmcnt(2)
    v_permlane32_swap_b32 v93, v92
    v_mfma_f32_16x16x32_bf16 v[52:55], a[48:51], v[64:67], v[52:55]
    ds_read_b128 v[80:83], v108 offset:16384
    global_load_dwordx4 v[220:223], v1, s[32:33] offset:-1024 sc1
    v_mfma_f32_16x16x32_bf16 v[56:59], a[128:131], v[64:67], v[56:59]
    v_fmac_f32 v48, v88, v36
    v_fmac_f32 v50, v88, v38
    v_mfma_f32_16x16x32_bf16 v[60:63], a[208:211], v[64:67], v[60:63]
    v_mul_f32 v96, v48, v48
    v_mul_f32 v50, v48, v50
    v_mfma_f32_16x16x32_bf16 v[52:55], a[52:55], v[68:71], v[52:55]
    ds_read_b128 v[84:87], v108 offset:17408
    v_fma_f32 v96, v96, v90, v89
    v_mfma_f32_16x16x32_bf16 v[56:59], a[132:135], v[68:71], v[56:59]
    v_mul_f32 v96, v96, v48
    v_exp_f32 v96, v96
    v_mfma_f32_16x16x32_bf16 v[60:63], a[212:215], v[68:71], v[60:63]
    s_waitcnt lgkmcnt(2)
    s_waitcnt vmcnt(8)
    s_barrier
    v_mfma_f32_16x16x32_bf16 v[52:55], a[56:59], v[72:75], v[52:55]
    ds_read_b128 v[64:67], v108 offset:18432
    v_fmac_f32 v49, v88, v37
    v_mfma_f32_16x16x32_bf16 v[56:59], a[136:139], v[72:75], v[56:59]
    s_add_u32 s34, s81, 102400
    s_add_u32 s34, s36, s34
    s_addc_u32 s35, s37, 0
    v_mfma_f32_16x16x32_bf16 v[60:63], a[216:219], v[72:75], v[60:63]
    s_add_u32 m0, s82, 143360
    v_fmac_f32 v51, v88, v39
    v_mul_f32 v97, v49, v49
    v_mfma_f32_16x16x32_bf16 v[52:55], a[60:63], v[76:79], v[52:55]
    ds_read_b128 v[68:71], v108 offset:19456
    global_load_lds_dwordx4 v1, s[34:35] offset:0 sc1
    v_mfma_f32_16x16x32_bf16 v[56:59], a[140:143], v[76:79], v[56:59]
    global_load_lds_dwordx4 v1, s[34:35] offset:1024 sc1
    v_mul_f32 v51, v49, v51
    v_mfma_f32_16x16x32_bf16 v[60:63], a[220:223], v[76:79], v[60:63]
    s_waitcnt lgkmcnt(2)
    v_fma_f32 v97, v97, v90, v89
    v_mul_f32 v97, v97, v49
    v_mfma_f32_16x16x32_bf16 v[52:55], a[64:67], v[80:83], v[52:55]
    ds_read_b128 v[72:75], v108 offset:20480
    global_load_lds_dwordx4 v1, s[34:35] offset:2048 sc1
    v_mfma_f32_16x16x32_bf16 v[56:59], a[144:147], v[80:83], v[56:59]
    v_exp_f32 v97, v97
    v_mfma_f32_16x16x32_bf16 v[60:63], a[224:227], v[80:83], v[60:63]
    v_fma_f32 v96, v96, v91, v91
    v_rcp_f32 v96, v96
    v_mfma_f32_16x16x32_bf16 v[52:55], a[68:71], v[84:87], v[52:55]
    ds_read_b128 v[76:79], v108 offset:21504
    v_fma_f32 v97, v97, v91, v91
    v_mfma_f32_16x16x32_bf16 v[56:59], a[148:151], v[84:87], v[56:59]
    v_rcp_f32 v97, v97
    v_mfma_f32_16x16x32_bf16 v[60:63], a[228:231], v[84:87], v[60:63]
    s_waitcnt lgkmcnt(2)
    v_mul_f32 v50, v50, v96
    v_mul_f32 v51, v51, v97
    v_cvt_pk_bf16_f32 v94, v50, v51
    v_mfma_f32_16x16x32_bf16 v[52:55], a[72:75], v[64:67], v[52:55]
    ds_read_b128 v[80:83], v108 offset:22528
    s_add_u32 s21, s91, 98304
    v_permlane32_swap_b32 v94, v95
    v_mfma_f32_16x16x32_bf16 v[56:59], a[152:155], v[64:67], v[56:59]
    global_load_lds_dwordx4 v1, s[34:35] offset:3072 sc1
    buffer_store_dwordx4 v[92:95], v110, s[36:39], s21 offen sc1
    v_mfma_f32_16x16x32_bf16 v[60:63], a[232:235], v[64:67], v[60:63]
    v_mfma_f32_16x16x32_bf16 v[52:55], a[76:79], v[68:71], v[52:55]
    ds_read_b128 v[84:87], v108 offset:23552
    v_mfma_f32_16x16x32_bf16 v[56:59], a[156:159], v[68:71], v[56:59]
    s_add_u32 m0, s82, 147456
    v_mfma_f32_16x16x32_bf16 v[60:63], a[236:239], v[68:71], v[60:63]
    s_waitcnt lgkmcnt(2)
    global_load_lds_dwordx4 v17, s[34:35] offset:0 sc1
    ds_read_b128 v[88:91], v109 offset:768
    v_mfma_f32_16x16x32_bf16 v[40:43], a[0:3], v[72:75], 0
    ds_read_b128 v[64:67], v108 offset:24576
    s_add_u32 s32, s89, 28672
    v_mfma_f32_16x16x32_bf16 v[44:47], a[80:83], v[72:75], 0
    s_add_u32 s32, s36, s32
    s_addc_u32 s33, s37, 0
    global_load_dwordx4 v[224:227], v1, s[32:33] offset:0 sc1
    v_mfma_f32_16x16x32_bf16 v[48:51], a[160:163], v[72:75], 0
    s_waitcnt lgkmcnt(1)
    v_fmac_f32 v52, v88, v28
    v_fmac_f32 v54, v88, v30
    v_mfma_f32_16x16x32_bf16 v[40:43], a[4:7], v[76:79], v[40:43]
    ds_read_b128 v[68:71], v108 offset:25600
    v_mul_f32 v96, v52, v52
    v_mfma_f32_16x16x32_bf16 v[44:47], a[84:87], v[76:79], v[44:47]
    global_load_dwordx4 v[228:231], v1, s[32:33] offset:1024 sc1
    v_mul_f32 v54, v52, v54
    v_mfma_f32_16x16x32_bf16 v[48:51], a[164:167], v[76:79], v[48:51]
    v_fma_f32 v96, v96, v90, v89
    v_mul_f32 v96, v96, v52
    v_mfma_f32_16x16x32_bf16 v[40:43], a[8:11], v[80:83], v[40:43]
    ds_read_b128 v[72:75], v108 offset:26624
    v_exp_f32 v96, v96
    v_mfma_f32_16x16x32_bf16 v[44:47], a[88:91], v[80:83], v[44:47]
    global_load_dwordx4 v[232:235], v1, s[32:33] offset:2048 sc1
    v_fmac_f32 v53, v88, v29
    v_mfma_f32_16x16x32_bf16 v[48:51], a[168:171], v[80:83], v[48:51]
    v_fmac_f32 v55, v88, v31
    v_mul_f32 v97, v53, v53
    v_mfma_f32_16x16x32_bf16 v[40:43], a[12:15], v[84:87], v[40:43]
    ds_read_b128 v[76:79], v108 offset:27648
    v_mul_f32 v55, v53, v55
    v_mfma_f32_16x16x32_bf16 v[44:47], a[92:95], v[84:87], v[44:47]
    v_fma_f32 v97, v97, v90, v89
    v_mul_f32 v97, v97, v53
    v_mfma_f32_16x16x32_bf16 v[48:51], a[172:175], v[84:87], v[48:51]
    s_waitcnt lgkmcnt(2)
    v_exp_f32 v97, v97
    v_mfma_f32_16x16x32_bf16 v[40:43], a[16:19], v[64:67], v[40:43]
    ds_read_b128 v[80:83], v108 offset:28672
    v_fma_f32 v96, v96, v91, v91
    v_mfma_f32_16x16x32_bf16 v[44:47], a[96:99], v[64:67], v[44:47]
    v_rcp_f32 v96, v96
    v_mfma_f32_16x16x32_bf16 v[48:51], a[176:179], v[64:67], v[48:51]
    v_fma_f32 v97, v97, v91, v91
    v_rcp_f32 v97, v97
    v_mfma_f32_16x16x32_bf16 v[40:43], a[20:23], v[68:71], v[40:43]
    ds_read_b128 v[84:87], v108 offset:29696
    v_mul_f32 v54, v54, v96
    v_mfma_f32_16x16x32_bf16 v[44:47], a[100:103], v[68:71], v[44:47]
    v_mul_f32 v55, v55, v97
    v_cvt_pk_bf16_f32 v92, v54, v55
    v_mfma_f32_16x16x32_bf16 v[48:51], a[180:183], v[68:71], v[48:51]
    s_waitcnt lgkmcnt(2)
    v_permlane16_swap_b32 v92, v95
    v_mfma_f32_16x16x32_bf16 v[40:43], a[24:27], v[72:75], v[40:43]
    ds_read_b128 v[64:67], v108 offset:30720
    global_load_dwordx4 v[236:239], v1, s[32:33] offset:3072 sc1
    v_mfma_f32_16x16x32_bf16 v[44:47], a[104:107], v[72:75], v[44:47]
    s_add_u32 s32, s89, 36864
    v_fmac_f32 v56, v88, v32
    v_fmac_f32 v58, v88, v34
    v_mfma_f32_16x16x32_bf16 v[48:51], a[184:187], v[72:75], v[48:51]
    s_add_u32 s32, s36, s32
    s_addc_u32 s33, s37, 0
    global_load_dwordx4 v[240:243], v1, s[32:33] offset:-4096 sc1
    v_mfma_f32_16x16x32_bf16 v[40:43], a[28:31], v[76:79], v[40:43]
    ds_read_b128 v[68:71], v108 offset:31744
    v_mul_f32 v96, v56, v56
    v_mfma_f32_16x16x32_bf16 v[44:47], a[108:111], v[76:79], v[44:47]
    global_load_dwordx4 v[244:247], v1, s[32:33] offset:-3072 sc1
    v_mul_f32 v58, v56, v58
    v_mfma_f32_16x16x32_bf16 v[48:51], a[188:191], v[76:79], v[48:51]
    s_waitcnt lgkmcnt(2)
    v_fma_f32 v96, v96, v90, v89
    v_mul_f32 v96, v96, v56
    v_mfma_f32_16x16x32_bf16 v[40:43], a[32:35], v[80:83], v[40:43]
    ds_read_b128 v[72:75], v108 offset:32768
    v_exp_f32 v96, v96
    v_mfma_f32_16x16x32_bf16 v[44:47], a[112:115], v[80:83], v[44:47]
    v_fmac_f32 v57, v88, v33
    v_fmac_f32 v59, v88, v35
    v_mfma_f32_16x16x32_bf16 v[48:51], a[192:195], v[80:83], v[48:51]
    v_mul_f32 v97, v57, v57
    v_mul_f32 v59, v57, v59
    v_mfma_f32_16x16x32_bf16 v[40:43], a[36:39], v[84:87], v[40:43]
    ds_read_b128 v[76:79], v108 offset:33792
    global_load_dwordx4 v[248:251], v1, s[32:33] offset:-2048 sc1
    v_mfma_f32_16x16x32_bf16 v[44:47], a[116:119], v[84:87], v[44:47]
    v_fma_f32 v97, v97, v90, v89
    v_mul_f32 v97, v97, v57
    v_mfma_f32_16x16x32_bf16 v[48:51], a[196:199], v[84:87], v[48:51]
    s_waitcnt lgkmcnt(2)
    v_exp_f32 v97, v97
    v_mfma_f32_16x16x32_bf16 v[40:43], a[40:43], v[64:67], v[40:43]
    ds_read_b128 v[80:83], v108 offset:34816
    v_fma_f32 v96, v96, v91, v91
    v_mfma_f32_16x16x32_bf16 v[44:47], a[120:123], v[64:67], v[44:47]
    v_rcp_f32 v96, v96
    v_mfma_f32_16x16x32_bf16 v[48:51], a[200:203], v[64:67], v[48:51]
    v_fma_f32 v97, v97, v91, v91
    v_rcp_f32 v97, v97
    v_mfma_f32_16x16x32_bf16 v[40:43], a[44:47], v[68:71], v[40:43]
    ds_read_b128 v[84:87], v108 offset:35840
    v_mul_f32 v58, v58, v96
    v_mfma_f32_16x16x32_bf16 v[44:47], a[124:127], v[68:71], v[44:47]
    v_mul_f32 v59, v59, v97
    v_cvt_pk_bf16_f32 v93, v58, v59
    v_mfma_f32_16x16x32_bf16 v[48:51], a[204:207], v[68:71], v[48:51]
    s_waitcnt lgkmcnt(2)
    v_permlane32_swap_b32 v93, v92
    v_mfma_f32_16x16x32_bf16 v[40:43], a[48:51], v[72:75], v[40:43]
    ds_read_b128 v[64:67], v108 offset:36864
    global_load_dwordx4 v[252:255], v1, s[32:33] offset:-1024 sc1
    v_mfma_f32_16x16x32_bf16 v[44:47], a[128:131], v[72:75], v[44:47]
    v_fmac_f32 v60, v88, v36
    v_fmac_f32 v62, v88, v38
    v_mfma_f32_16x16x32_bf16 v[48:51], a[208:211], v[72:75], v[48:51]
    v_mul_f32 v96, v60, v60
    v_mul_f32 v62, v60, v62
    v_mfma_f32_16x16x32_bf16 v[40:43], a[52:55], v[76:79], v[40:43]
    ds_read_b128 v[68:71], v108 offset:37888
    v_fma_f32 v96, v96, v90, v89
    v_mfma_f32_16x16x32_bf16 v[44:47], a[132:135], v[76:79], v[44:47]
    v_mul_f32 v96, v96, v60
    v_exp_f32 v96, v96
    v_mfma_f32_16x16x32_bf16 v[48:51], a[212:215], v[76:79], v[48:51]
    s_waitcnt lgkmcnt(2)
    s_waitcnt vmcnt(8)
    s_barrier
    v_mfma_f32_16x16x32_bf16 v[40:43], a[56:59], v[80:83], v[40:43]
    ds_read_b128 v[72:75], v108 offset:38912
    v_fmac_f32 v61, v88, v37
    v_mfma_f32_16x16x32_bf16 v[44:47], a[136:139], v[80:83], v[44:47]
    s_add_u32 s34, s81, 122880
    s_add_u32 s34, s36, s34
    s_addc_u32 s35, s37, 0
    v_mfma_f32_16x16x32_bf16 v[48:51], a[216:219], v[80:83], v[48:51]
    s_add_u32 m0, s82, 102400
    v_fmac_f32 v63, v88, v39
    v_mul_f32 v97, v61, v61
    v_mfma_f32_16x16x32_bf16 v[40:43], a[60:63], v[84:87], v[40:43]
    ds_read_b128 v[76:79], v108 offset:39936
    global_load_lds_dwordx4 v1, s[34:35] offset:0 sc1
    v_mfma_f32_16x16x32_bf16 v[44:47], a[140:143], v[84:87], v[44:47]
    global_load_lds_dwordx4 v1, s[34:35] offset:1024 sc1
    v_mul_f32 v63, v61, v63
    v_mfma_f32_16x16x32_bf16 v[48:51], a[220:223], v[84:87], v[48:51]
    s_waitcnt lgkmcnt(2)
    v_fma_f32 v97, v97, v90, v89
    v_mul_f32 v97, v97, v61
    v_mfma_f32_16x16x32_bf16 v[40:43], a[64:67], v[64:67], v[40:43]
    ds_read_b128 v[80:83], v108 offset:40960
    global_load_lds_dwordx4 v1, s[34:35] offset:2048 sc1
    v_mfma_f32_16x16x32_bf16 v[44:47], a[144:147], v[64:67], v[44:47]
    v_exp_f32 v97, v97
    v_mfma_f32_16x16x32_bf16 v[48:51], a[224:227], v[64:67], v[48:51]
    v_fma_f32 v96, v96, v91, v91
    v_rcp_f32 v96, v96
    v_mfma_f32_16x16x32_bf16 v[40:43], a[68:71], v[68:71], v[40:43]
    ds_read_b128 v[84:87], v108 offset:41984
    v_fma_f32 v97, v97, v91, v91
    v_mfma_f32_16x16x32_bf16 v[44:47], a[148:151], v[68:71], v[44:47]
    v_rcp_f32 v97, v97
    v_mfma_f32_16x16x32_bf16 v[48:51], a[228:231], v[68:71], v[48:51]
    s_waitcnt lgkmcnt(2)
    v_mul_f32 v62, v62, v96
    v_mul_f32 v63, v63, v97
    v_cvt_pk_bf16_f32 v94, v62, v63
    v_mfma_f32_16x16x32_bf16 v[40:43], a[72:75], v[72:75], v[40:43]
    ds_read_b128 v[64:67], v108 offset:43008
    s_add_u32 s21, s91, 147456
    v_permlane32_swap_b32 v94, v95
    v_mfma_f32_16x16x32_bf16 v[44:47], a[152:155], v[72:75], v[44:47]
    global_load_lds_dwordx4 v1, s[34:35] offset:3072 sc1
    buffer_store_dwordx4 v[92:95], v110, s[36:39], s21 offen sc1
    v_mfma_f32_16x16x32_bf16 v[48:51], a[232:235], v[72:75], v[48:51]
    v_mfma_f32_16x16x32_bf16 v[40:43], a[76:79], v[76:79], v[40:43]
    ds_read_b128 v[68:71], v108 offset:44032
    v_mfma_f32_16x16x32_bf16 v[44:47], a[156:159], v[76:79], v[44:47]
    s_add_u32 m0, s82, 106496
    v_mfma_f32_16x16x32_bf16 v[48:51], a[236:239], v[76:79], v[48:51]
    s_waitcnt lgkmcnt(2)
    global_load_lds_dwordx4 v17, s[34:35] offset:0 sc1
    ds_read_b128 v[88:91], v109 offset:1024
    v_mfma_f32_16x16x32_bf16 v[52:55], a[0:3], v[80:83], 0
    ds_read_b128 v[72:75], v108 offset:45056
    v_mfma_f32_16x16x32_bf16 v[56:59], a[80:83], v[80:83], 0
    s_add_u32 s32, s89, 36864
    s_add_u32 s32, s36, s32
    s_addc_u32 s33, s37, 0
    v_mfma_f32_16x16x32_bf16 v[60:63], a[160:163], v[80:83], 0
    s_add_u32 m0, s80, 2048
    s_waitcnt lgkmcnt(1)
    v_fmac_f32 v40, v88, v28
    v_fmac_f32 v42, v88, v30
    v_mfma_f32_16x16x32_bf16 v[52:55], a[4:7], v[84:87], v[52:55]
    ds_read_b128 v[76:79], v108 offset:46080
    global_load_lds_dwordx4 v1, s[32:33] offset:0 sc1
    v_mfma_f32_16x16x32_bf16 v[56:59], a[84:87], v[84:87], v[56:59]
    global_load_lds_dwordx4 v1, s[32:33] offset:1024 sc1
    v_mul_f32 v96, v40, v40
    v_mfma_f32_16x16x32_bf16 v[60:63], a[164:167], v[84:87], v[60:63]
    v_mul_f32 v42, v40, v42
    v_fma_f32 v96, v96, v90, v89
    v_mfma_f32_16x16x32_bf16 v[52:55], a[8:11], v[64:67], v[52:55]
    ds_read_b128 v[80:83], v108 offset:47104
    v_mul_f32 v96, v96, v40
    v_mfma_f32_16x16x32_bf16 v[56:59], a[88:91], v[64:67], v[56:59]
    v_exp_f32 v96, v96
    v_mfma_f32_16x16x32_bf16 v[60:63], a[168:171], v[64:67], v[60:63]
    global_load_lds_dwordx4 v1, s[32:33] offset:2048 sc1
    v_fmac_f32 v41, v88, v29
    v_mfma_f32_16x16x32_bf16 v[52:55], a[12:15], v[68:71], v[52:55]
    ds_read_b128 v[84:87], v108 offset:48128
    v_fmac_f32 v43, v88, v31
    v_mfma_f32_16x16x32_bf16 v[56:59], a[92:95], v[68:71], v[56:59]
    v_mul_f32 v97, v41, v41
    v_mul_f32 v43, v41, v43
    v_mfma_f32_16x16x32_bf16 v[60:63], a[172:175], v[68:71], v[60:63]
    s_waitcnt lgkmcnt(2)
    v_fma_f32 v97, v97, v90, v89
    v_mul_f32 v97, v97, v41
    v_mfma_f32_16x16x32_bf16 v[52:55], a[16:19], v[72:75], v[52:55]
    ds_read_b128 v[64:67], v108 offset:49152
    global_load_lds_dwordx4 v1, s[32:33] offset:3072 sc1
    v_mfma_f32_16x16x32_bf16 v[56:59], a[96:99], v[72:75], v[56:59]
    v_exp_f32 v97, v97
    v_mfma_f32_16x16x32_bf16 v[60:63], a[176:179], v[72:75], v[60:63]
    v_fma_f32 v96, v96, v91, v91
    v_rcp_f32 v96, v96
    v_mfma_f32_16x16x32_bf16 v[52:55], a[20:23], v[76:79], v[52:55]
    ds_read_b128 v[68:71], v108 offset:50176
    v_fma_f32 v97, v97, v91, v91
    v_mfma_f32_16x16x32_bf16 v[56:59], a[100:103], v[76:79], v[56:59]
    v_rcp_f32 v97, v97
    v_mfma_f32_16x16x32_bf16 v[60:63], a[180:183], v[76:79], v[60:63]
    s_waitcnt lgkmcnt(2)
    v_mul_f32 v42, v42, v96
    v_mul_f32 v43, v43, v97
    v_mfma_f32_16x16x32_bf16 v[52:55], a[24:27], v[80:83], v[52:55]
    ds_read_b128 v[72:75], v108 offset:51200
    v_cvt_pk_bf16_f32 v92, v42, v43
    v_mfma_f32_16x16x32_bf16 v[56:59], a[104:107], v[80:83], v[56:59]
    s_add_u32 s32, s89, 40960
    v_permlane16_swap_b32 v92, v95
    v_mfma_f32_16x16x32_bf16 v[60:63], a[184:187], v[80:83], v[60:63]
    s_add_u32 s32, s36, s32
    s_addc_u32 s33, s37, 0
    v_fmac_f32 v44, v88, v32
    v_mfma_f32_16x16x32_bf16 v[52:55], a[28:31], v[84:87], v[52:55]
    ds_read_b128 v[76:79], v108 offset:52224
    v_fmac_f32 v46, v88, v34
    v_mfma_f32_16x16x32_bf16 v[56:59], a[108:111], v[84:87], v[56:59]
    s_add_u32 m0, s80, 6144
    v_mul_f32 v96, v44, v44
    v_mul_f32 v46, v44, v46
    v_mfma_f32_16x16x32_bf16 v[60:63], a[188:191], v[84:87], v[60:63]
    s_waitcnt lgkmcnt(2)
    global_load_lds_dwordx4 v1, s[32:33] offset:0 sc1
    v_fma_f32 v96, v96, v90, v89
    v_mfma_f32_16x16x32_bf16 v[52:55], a[32:35], v[64:67], v[52:55]
    ds_read_b128 v[80:83], v108 offset:53248
    v_mul_f32 v96, v96, v44
    v_mfma_f32_16x16x32_bf16 v[56:59], a[112:115], v[64:67], v[56:59]
    v_exp_f32 v96, v96
    v_mfma_f32_16x16x32_bf16 v[60:63], a[192:195], v[64:67], v[60:63]
    global_load_lds_dwordx4 v1, s[32:33] offset:1024 sc1
    v_fmac_f32 v45, v88, v33
    v_mfma_f32_16x16x32_bf16 v[52:55], a[36:39], v[68:71], v[52:55]
    ds_read_b128 v[84:87], v108 offset:54272
    global_load_lds_dwordx4 v1, s[32:33] offset:2048 sc1
    v_mfma_f32_16x16x32_bf16 v[56:59], a[116:119], v[68:71], v[56:59]
    v_fmac_f32 v47, v88, v35
    v_mul_f32 v97, v45, v45
    v_mfma_f32_16x16x32_bf16 v[60:63], a[196:199], v[68:71], v[60:63]
    s_waitcnt lgkmcnt(2)
    v_mul_f32 v47, v45, v47
    v_fma_f32 v97, v97, v90, v89
    v_mfma_f32_16x16x32_bf16 v[52:55], a[40:43], v[72:75], v[52:55]
    ds_read_b128 v[64:67], v108 offset:55296
    v_mul_f32 v97, v97, v45
    v_mfma_f32_16x16x32_bf16 v[56:59], a[120:123], v[72:75], v[56:59]
    v_exp_f32 v97, v97
    v_mfma_f32_16x16x32_bf16 v[60:63], a[200:203], v[72:75], v[60:63]
    v_fma_f32 v96, v96, v91, v91
    v_rcp_f32 v96, v96
    v_mfma_f32_16x16x32_bf16 v[52:55], a[44:47], v[76:79], v[52:55]
    ds_read_b128 v[68:71], v108 offset:56320
    v_fma_f32 v97, v97, v91, v91
    v_mfma_f32_16x16x32_bf16 v[56:59], a[124:127], v[76:79], v[56:59]
    v_rcp_f32 v97, v97
    v_mfma_f32_16x16x32_bf16 v[60:63], a[204:207], v[76:79], v[60:63]
    s_waitcnt lgkmcnt(2)
    v_mul_f32 v46, v46, v96
    v_mul_f32 v47, v47, v97
    v_mfma_f32_16x16x32_bf16 v[52:55], a[48:51], v[80:83], v[52:55]
    ds_read_b128 v[72:75], v108 offset:57344
    v_cvt_pk_bf16_f32 v93, v46, v47
    v_mfma_f32_16x16x32_bf16 v[56:59], a[128:131], v[80:83], v[56:59]
    s_nop 0
    v_permlane32_swap_b32 v93, v92
    v_mfma_f32_16x16x32_bf16 v[60:63], a[208:211], v[80:83], v[60:63]
    global_load_lds_dwordx4 v1, s[32:33] offset:3072 sc1
    v_fmac_f32 v48, v88, v36
    v_mfma_f32_16x16x32_bf16 v[52:55], a[52:55], v[84:87], v[52:55]
    ds_read_b128 v[76:79], v108 offset:58368
    v_fmac_f32 v50, v88, v38
    v_mfma_f32_16x16x32_bf16 v[56:59], a[132:135], v[84:87], v[56:59]
    v_mul_f32 v96, v48, v48
    v_mul_f32 v50, v48, v50
    v_mfma_f32_16x16x32_bf16 v[60:63], a[212:215], v[84:87], v[60:63]
    s_waitcnt lgkmcnt(2)
    s_waitcnt vmcnt(8)
    s_barrier
    s_lshl_b32 s72, s64, 11
    s_lshl_b32 s73, s65, 7
    s_add_u32 s72, s72, s73
    s_add_u32 s72, s72, 135168
    buffer_store_dwordx2 v[8:9], v5, s[36:39], s72 offen sc1
    v_mfma_f32_16x16x32_bf16 v[52:55], a[56:59], v[64:67], v[52:55]
    ds_read_b128 v[80:83], v108 offset:59392
    v_fma_f32 v96, v96, v90, v89
    v_mfma_f32_16x16x32_bf16 v[56:59], a[136:139], v[64:67], v[56:59]
    s_add_u32 s34, s81, 143360
    s_add_u32 s34, s36, s34
    s_addc_u32 s35, s37, 0
    v_mfma_f32_16x16x32_bf16 v[60:63], a[216:219], v[64:67], v[60:63]
    s_add_u32 m0, s82, 122880
    v_mul_f32 v96, v96, v48
    v_exp_f32 v96, v96
    v_mfma_f32_16x16x32_bf16 v[52:55], a[60:63], v[68:71], v[52:55]
    ds_read_b128 v[84:87], v108 offset:60416
    global_load_lds_dwordx4 v1, s[34:35] offset:0 sc1
    v_mfma_f32_16x16x32_bf16 v[56:59], a[140:143], v[68:71], v[56:59]
    global_load_lds_dwordx4 v1, s[34:35] offset:1024 sc1
    v_fmac_f32 v49, v88, v37
    v_mfma_f32_16x16x32_bf16 v[60:63], a[220:223], v[68:71], v[60:63]
    s_waitcnt lgkmcnt(2)
    v_fmac_f32 v51, v88, v39
    v_mul_f32 v97, v49, v49
    v_mfma_f32_16x16x32_bf16 v[52:55], a[64:67], v[72:75], v[52:55]
    ds_read_b128 v[64:67], v108 offset:0
    v_mul_f32 v51, v49, v51
    v_mfma_f32_16x16x32_bf16 v[56:59], a[144:147], v[72:75], v[56:59]
    v_fma_f32 v97, v97, v90, v89
    v_mul_f32 v97, v97, v49
    v_mfma_f32_16x16x32_bf16 v[60:63], a[224:227], v[72:75], v[60:63]
    v_exp_f32 v97, v97
    v_mfma_f32_16x16x32_bf16 v[52:55], a[68:71], v[76:79], v[52:55]
    ds_read_b128 v[68:71], v108 offset:1024
    v_fma_f32 v96, v96, v91, v91
    v_mfma_f32_16x16x32_bf16 v[56:59], a[148:151], v[76:79], v[56:59]
    global_load_lds_dwordx4 v1, s[34:35] offset:2048 sc1
    v_rcp_f32 v96, v96
    v_fma_f32 v97, v97, v91, v91
    v_rcp_f32 v97, v97
    v_mfma_f32_16x16x32_bf16 v[60:63], a[228:231], v[76:79], v[60:63]
    s_waitcnt lgkmcnt(2)
    v_mul_f32 v50, v50, v96
    v_mul_f32 v51, v51, v97
    v_cvt_pk_bf16_f32 v94, v50, v51
    v_mfma_f32_16x16x32_bf16 v[52:55], a[72:75], v[80:83], v[52:55]
    ds_read_b128 v[72:75], v108 offset:2048
    s_add_u32 s21, s91, 196608
    v_permlane32_swap_b32 v94, v95
    v_mfma_f32_16x16x32_bf16 v[56:59], a[152:155], v[80:83], v[56:59]
    global_load_lds_dwordx4 v1, s[34:35] offset:3072 sc1
    buffer_store_dwordx4 v[92:95], v110, s[36:39], s21 offen sc1
    v_mfma_f32_16x16x32_bf16 v[60:63], a[232:235], v[80:83], v[60:63]
    v_mfma_f32_16x16x32_bf16 v[52:55], a[76:79], v[84:87], v[52:55]
    ds_read_b128 v[76:79], v108 offset:3072
    v_mfma_f32_16x16x32_bf16 v[56:59], a[156:159], v[84:87], v[56:59]
    s_add_u32 m0, s82, 126976
    v_mfma_f32_16x16x32_bf16 v[60:63], a[236:239], v[84:87], v[60:63]
    s_waitcnt lgkmcnt(2)
    global_load_lds_dwordx4 v17, s[34:35] offset:0 sc1
    ds_read_b128 v[88:91], v109 offset:1280
    v_mfma_f32_16x16x32_bf16 v[40:43], a[0:3], v[64:67], 0
    ds_read_b128 v[80:83], v108 offset:4096
    v_mfma_f32_16x16x32_bf16 v[44:47], a[80:83], v[64:67], 0
    s_add_u32 s32, s89, 45056
    s_add_u32 s32, s36, s32
    s_addc_u32 s33, s37, 0
    v_mfma_f32_16x16x32_bf16 v[48:51], a[160:163], v[64:67], 0
    s_add_u32 m0, s80, 10240
    s_waitcnt lgkmcnt(1)
    v_fmac_f32 v52, v88, v28
    v_fmac_f32 v54, v88, v30
    v_mfma_f32_16x16x32_bf16 v[40:43], a[4:7], v[68:71], v[40:43]
    ds_read_b128 v[84:87], v108 offset:5120
    global_load_lds_dwordx4 v1, s[32:33] offset:0 sc1
    v_mfma_f32_16x16x32_bf16 v[44:47], a[84:87], v[68:71], v[44:47]
    global_load_lds_dwordx4 v1, s[32:33] offset:1024 sc1
    v_mul_f32 v96, v52, v52
    v_mfma_f32_16x16x32_bf16 v[48:51], a[164:167], v[68:71], v[48:51]
    v_mul_f32 v54, v52, v54
    v_fma_f32 v96, v96, v90, v89
    v_mfma_f32_16x16x32_bf16 v[40:43], a[8:11], v[72:75], v[40:43]
    ds_read_b128 v[64:67], v108 offset:6144
    v_mul_f32 v96, v96, v52
    v_mfma_f32_16x16x32_bf16 v[44:47], a[88:91], v[72:75], v[44:47]
    v_exp_f32 v96, v96
    v_mfma_f32_16x16x32_bf16 v[48:51], a[168:171], v[72:75], v[48:51]
    global_load_lds_dwordx4 v1, s[32:33] offset:2048 sc1
    v_fmac_f32 v53, v88, v29
    v_mfma_f32_16x16x32_bf16 v[40:43], a[12:15], v[76:79], v[40:43]
    ds_read_b128 v[68:71], v108 offset:7168
    v_fmac_f32 v55, v88, v31
    v_mfma_f32_16x16x32_bf16 v[44:47], a[92:95], v[76:79], v[44:47]
    v_mul_f32 v97, v53, v53
    v_mul_f32 v55, v53, v55
    v_mfma_f32_16x16x32_bf16 v[48:51], a[172:175], v[76:79], v[48:51]
    s_waitcnt lgkmcnt(2)
    v_fma_f32 v97, v97, v90, v89
    v_mul_f32 v97, v97, v53
    v_mfma_f32_16x16x32_bf16 v[40:43], a[16:19], v[80:83], v[40:43]
    ds_read_b128 v[72:75], v108 offset:8192
    global_load_lds_dwordx4 v1, s[32:33] offset:3072 sc1
    v_mfma_f32_16x16x32_bf16 v[44:47], a[96:99], v[80:83], v[44:47]
    s_add_u32 s32, s89, 49152
    v_exp_f32 v97, v97
    v_mfma_f32_16x16x32_bf16 v[48:51], a[176:179], v[80:83], v[48:51]
    s_add_u32 s32, s36, s32
    s_addc_u32 s33, s37, 0
    v_fma_f32 v96, v96, v91, v91
    v_mfma_f32_16x16x32_bf16 v[40:43], a[20:23], v[84:87], v[40:43]
    ds_read_b128 v[76:79], v108 offset:9216
    v_rcp_f32 v96, v96
    v_mfma_f32_16x16x32_bf16 v[44:47], a[100:103], v[84:87], v[44:47]
    v_fma_f32 v97, v97, v91, v91
    v_rcp_f32 v97, v97
    v_mfma_f32_16x16x32_bf16 v[48:51], a[180:183], v[84:87], v[48:51]
    s_waitcnt lgkmcnt(2)
    v_mul_f32 v54, v54, v96
    v_mul_f32 v55, v55, v97
    v_mfma_f32_16x16x32_bf16 v[40:43], a[24:27], v[64:67], v[40:43]
    ds_read_b128 v[80:83], v108 offset:10240
    v_cvt_pk_bf16_f32 v92, v54, v55
    v_mfma_f32_16x16x32_bf16 v[44:47], a[104:107], v[64:67], v[44:47]
    s_add_u32 m0, s80, 14336
    v_permlane16_swap_b32 v92, v95
    v_mfma_f32_16x16x32_bf16 v[48:51], a[184:187], v[64:67], v[48:51]
    global_load_lds_dwordx4 v1, s[32:33] offset:0 sc1
    v_fmac_f32 v56, v88, v32
    v_mfma_f32_16x16x32_bf16 v[40:43], a[28:31], v[68:71], v[40:43]
    ds_read_b128 v[84:87], v108 offset:11264
    global_load_lds_dwordx4 v1, s[32:33] offset:1024 sc1
    v_mfma_f32_16x16x32_bf16 v[44:47], a[108:111], v[68:71], v[44:47]
    v_fmac_f32 v58, v88, v34
    v_mul_f32 v96, v56, v56
    v_mfma_f32_16x16x32_bf16 v[48:51], a[188:191], v[68:71], v[48:51]
    s_waitcnt lgkmcnt(2)
    v_mul_f32 v58, v56, v58
    v_fma_f32 v96, v96, v90, v89
    v_mfma_f32_16x16x32_bf16 v[40:43], a[32:35], v[72:75], v[40:43]
    ds_read_b128 v[64:67], v108 offset:12288
    v_mul_f32 v96, v96, v56
    v_mfma_f32_16x16x32_bf16 v[44:47], a[112:115], v[72:75], v[44:47]
    v_exp_f32 v96, v96
    v_mfma_f32_16x16x32_bf16 v[48:51], a[192:195], v[72:75], v[48:51]
    global_load_lds_dwordx4 v1, s[32:33] offset:2048 sc1
    v_fmac_f32 v57, v88, v33
    v_mfma_f32_16x16x32_bf16 v[40:43], a[36:39], v[76:79], v[40:43]
    ds_read_b128 v[68:71], v108 offset:13312
    v_fmac_f32 v59, v88, v35
    v_mfma_f32_16x16x32_bf16 v[44:47], a[116:119], v[76:79], v[44:47]
    v_mul_f32 v97, v57, v57
    v_mul_f32 v59, v57, v59
    v_mfma_f32_16x16x32_bf16 v[48:51], a[196:199], v[76:79], v[48:51]
    s_waitcnt lgkmcnt(2)
    v_fma_f32 v97, v97, v90, v89
    v_mul_f32 v97, v97, v57
    v_mfma_f32_16x16x32_bf16 v[40:43], a[40:43], v[80:83], v[40:43]
    ds_read_b128 v[72:75], v108 offset:14336
    v_exp_f32 v97, v97
    v_mfma_f32_16x16x32_bf16 v[44:47], a[120:123], v[80:83], v[44:47]
    global_load_lds_dwordx4 v1, s[32:33] offset:3072 sc1
    v_fma_f32 v96, v96, v91, v91
    v_mfma_f32_16x16x32_bf16 v[48:51], a[200:203], v[80:83], v[48:51]
    v_rcp_f32 v96, v96
    v_mfma_f32_16x16x32_bf16 v[40:43], a[44:47], v[84:87], v[40:43]
    ds_read_b128 v[76:79], v108 offset:15360
    v_fma_f32 v97, v97, v91, v91
    v_mfma_f32_16x16x32_bf16 v[44:47], a[124:127], v[84:87], v[44:47]
    v_rcp_f32 v97, v97
    v_mfma_f32_16x16x32_bf16 v[48:51], a[204:207], v[84:87], v[48:51]
    s_waitcnt lgkmcnt(2)
    v_mul_f32 v58, v58, v96
    v_mul_f32 v59, v59, v97
    v_mfma_f32_16x16x32_bf16 v[40:43], a[48:51], v[64:67], v[40:43]
    ds_read_b128 v[80:83], v108 offset:16384
    v_cvt_pk_bf16_f32 v93, v58, v59
    v_mfma_f32_16x16x32_bf16 v[44:47], a[128:131], v[64:67], v[44:47]
    s_add_u32 s32, s89, 53248
    v_permlane32_swap_b32 v93, v92
    v_mfma_f32_16x16x32_bf16 v[48:51], a[208:211], v[64:67], v[48:51]
    s_add_u32 s32, s36, s32
    s_addc_u32 s33, s37, 0
    v_fmac_f32 v60, v88, v36
    v_mfma_f32_16x16x32_bf16 v[40:43], a[52:55], v[68:71], v[40:43]
    ds_read_b128 v[84:87], v108 offset:17408
    v_fmac_f32 v62, v88, v38
    v_mfma_f32_16x16x32_bf16 v[44:47], a[132:135], v[68:71], v[44:47]
    s_add_u32 m0, s80, 18432
    v_mul_f32 v96, v60, v60
    v_mul_f32 v62, v60, v62
    v_mfma_f32_16x16x32_bf16 v[48:51], a[212:215], v[68:71], v[48:51]
    s_waitcnt lgkmcnt(2)
    s_waitcnt vmcnt(8)
    s_barrier
    v_mfma_f32_16x16x32_bf16 v[40:43], a[56:59], v[72:75], v[40:43]
    ds_read_b128 v[64:67], v108 offset:18432
    global_load_lds_dwordx4 v1, s[32:33] offset:0 sc1
    v_mfma_f32_16x16x32_bf16 v[44:47], a[136:139], v[72:75], v[44:47]
    v_fma_f32 v96, v96, v90, v89
    v_mul_f32 v96, v96, v60
    v_mfma_f32_16x16x32_bf16 v[48:51], a[216:219], v[72:75], v[48:51]
    v_exp_f32 v96, v96
    v_mfma_f32_16x16x32_bf16 v[40:43], a[60:63], v[76:79], v[40:43]
    ds_read_b128 v[68:71], v108 offset:19456
    global_load_lds_dwordx4 v1, s[32:33] offset:1024 sc1
    v_mfma_f32_16x16x32_bf16 v[44:47], a[140:143], v[76:79], v[44:47]
    global_load_lds_dwordx4 v1, s[32:33] offset:2048 sc1
    v_fmac_f32 v61, v88, v37
    v_mfma_f32_16x16x32_bf16 v[48:51], a[220:223], v[76:79], v[48:51]
    s_waitcnt lgkmcnt(2)
    v_fmac_f32 v63, v88, v39
    v_mul_f32 v97, v61, v61
    v_mfma_f32_16x16x32_bf16 v[40:43], a[64:67], v[80:83], v[40:43]
    ds_read_b128 v[72:75], v108 offset:20480
    v_mul_f32 v63, v61, v63
    v_mfma_f32_16x16x32_bf16 v[44:47], a[144:147], v[80:83], v[44:47]
    v_fma_f32 v97, v97, v90, v89
    v_mul_f32 v97, v97, v61
    v_mfma_f32_16x16x32_bf16 v[48:51], a[224:227], v[80:83], v[48:51]
    v_exp_f32 v97, v97
    v_mfma_f32_16x16x32_bf16 v[40:43], a[68:71], v[84:87], v[40:43]
    ds_read_b128 v[76:79], v108 offset:21504
    v_fma_f32 v96, v96, v91, v91
    v_mfma_f32_16x16x32_bf16 v[44:47], a[148:151], v[84:87], v[44:47]
    v_rcp_f32 v96, v96
    v_fma_f32 v97, v97, v91, v91
    v_rcp_f32 v97, v97
    v_mfma_f32_16x16x32_bf16 v[48:51], a[228:231], v[84:87], v[48:51]
    s_waitcnt lgkmcnt(2)
    v_mul_f32 v62, v62, v96
    v_mul_f32 v63, v63, v97
    v_cvt_pk_bf16_f32 v94, v62, v63
    v_mfma_f32_16x16x32_bf16 v[40:43], a[72:75], v[64:67], v[40:43]
    ds_read_b128 v[80:83], v108 offset:22528
    s_add_u32 s21, s91, 245760
    v_permlane32_swap_b32 v94, v95
    v_mfma_f32_16x16x32_bf16 v[44:47], a[152:155], v[64:67], v[44:47]
    buffer_store_dwordx4 v[92:95], v110, s[36:39], s21 offen sc1
    v_mfma_f32_16x16x32_bf16 v[48:51], a[232:235], v[64:67], v[48:51]
    global_load_lds_dwordx4 v1, s[32:33] offset:3072 sc1
    v_mfma_f32_16x16x32_bf16 v[40:43], a[76:79], v[68:71], v[40:43]
    ds_read_b128 v[84:87], v108 offset:23552
    v_mfma_f32_16x16x32_bf16 v[44:47], a[156:159], v[68:71], v[44:47]
    v_mfma_f32_16x16x32_bf16 v[48:51], a[236:239], v[68:71], v[48:51]
    s_waitcnt lgkmcnt(2)
    ds_read_b128 v[88:91], v109 offset:1536
    v_mfma_f32_16x16x32_bf16 v[52:55], a[0:3], v[72:75], 0
    ds_read_b128 v[64:67], v108 offset:24576
    s_add_u32 s23, s84, 0
    buffer_load_dwordx2 v[104:105], v6, s[36:39], s23 offen sc1
    v_mfma_f32_16x16x32_bf16 v[56:59], a[80:83], v[72:75], 0
    s_add_u32 s32, s89, 57344
    s_add_u32 s32, s36, s32
    s_addc_u32 s33, s37, 0
    v_mfma_f32_16x16x32_bf16 v[60:63], a[160:163], v[72:75], 0
    s_add_u32 m0, s80, 22528
    s_waitcnt lgkmcnt(1)
    v_fmac_f32 v40, v88, v28
    v_fmac_f32 v42, v88, v30
    v_mfma_f32_16x16x32_bf16 v[52:55], a[4:7], v[76:79], v[52:55]
    ds_read_b128 v[68:71], v108 offset:25600
    global_load_lds_dwordx4 v1, s[32:33] offset:0 sc1
    v_mfma_f32_16x16x32_bf16 v[56:59], a[84:87], v[76:79], v[56:59]
    global_load_lds_dwordx4 v1, s[32:33] offset:1024 sc1
    v_mul_f32 v96, v40, v40
    v_mfma_f32_16x16x32_bf16 v[60:63], a[164:167], v[76:79], v[60:63]
    v_mul_f32 v42, v40, v42
    v_fma_f32 v96, v96, v90, v89
    v_mfma_f32_16x16x32_bf16 v[52:55], a[8:11], v[80:83], v[52:55]
    ds_read_b128 v[72:75], v108 offset:26624
    v_mul_f32 v96, v96, v40
    v_mfma_f32_16x16x32_bf16 v[56:59], a[88:91], v[80:83], v[56:59]
    v_exp_f32 v96, v96
    v_mfma_f32_16x16x32_bf16 v[60:63], a[168:171], v[80:83], v[60:63]
    v_fmac_f32 v41, v88, v29
    v_fmac_f32 v43, v88, v31
    v_mfma_f32_16x16x32_bf16 v[52:55], a[12:15], v[84:87], v[52:55]
    ds_read_b128 v[76:79], v108 offset:27648
    v_mul_f32 v97, v41, v41
    v_mfma_f32_16x16x32_bf16 v[56:59], a[92:95], v[84:87], v[56:59]
    v_mul_f32 v43, v41, v43
    v_fma_f32 v97, v97, v90, v89
    v_mfma_f32_16x16x32_bf16 v[60:63], a[172:175], v[84:87], v[60:63]
    s_waitcnt lgkmcnt(2)
    v_mul_f32 v97, v97, v41
    v_exp_f32 v97, v97
    v_mfma_f32_16x16x32_bf16 v[52:55], a[16:19], v[64:67], v[52:55]
    ds_read_b128 v[80:83], v108 offset:28672
    v_fma_f32 v96, v96, v91, v91
    v_mfma_f32_16x16x32_bf16 v[56:59], a[96:99], v[64:67], v[56:59]
    v_rcp_f32 v96, v96
    v_mfma_f32_16x16x32_bf16 v[60:63], a[176:179], v[64:67], v[60:63]
    global_load_lds_dwordx4 v1, s[32:33] offset:2048 sc1
    v_fma_f32 v97, v97, v91, v91
    v_mfma_f32_16x16x32_bf16 v[52:55], a[20:23], v[68:71], v[52:55]
    ds_read_b128 v[84:87], v108 offset:29696
    global_load_lds_dwordx4 v1, s[32:33] offset:3072 sc1
    v_mfma_f32_16x16x32_bf16 v[56:59], a[100:103], v[68:71], v[56:59]
    v_rcp_f32 v97, v97
    v_mfma_f32_16x16x32_bf16 v[60:63], a[180:183], v[68:71], v[60:63]
    s_waitcnt lgkmcnt(2)
    v_mul_f32 v42, v42, v96
    v_mul_f32 v43, v43, v97
    v_mfma_f32_16x16x32_bf16 v[52:55], a[24:27], v[72:75], v[52:55]
    ds_read_b128 v[64:67], v108 offset:30720
    v_cvt_pk_bf16_f32 v92, v42, v43
    v_mfma_f32_16x16x32_bf16 v[56:59], a[104:107], v[72:75], v[56:59]
    s_nop 0
    v_permlane16_swap_b32 v92, v95
    v_mfma_f32_16x16x32_bf16 v[60:63], a[184:187], v[72:75], v[60:63]
    v_fmac_f32 v44, v88, v32
    v_fmac_f32 v46, v88, v34
    v_mfma_f32_16x16x32_bf16 v[52:55], a[28:31], v[76:79], v[52:55]
    ds_read_b128 v[68:71], v108 offset:31744
    v_mul_f32 v96, v44, v44
    v_mfma_f32_16x16x32_bf16 v[56:59], a[108:111], v[76:79], v[56:59]
    v_mul_f32 v46, v44, v46
    v_fma_f32 v96, v96, v90, v89
    v_mfma_f32_16x16x32_bf16 v[60:63], a[188:191], v[76:79], v[60:63]
    s_waitcnt lgkmcnt(2)
    v_mul_f32 v96, v96, v44
    v_exp_f32 v96, v96
    v_mfma_f32_16x16x32_bf16 v[52:55], a[32:35], v[80:83], v[52:55]
    ds_read_b128 v[72:75], v108 offset:32768
    v_fmac_f32 v45, v88, v33
    v_mfma_f32_16x16x32_bf16 v[56:59], a[112:115], v[80:83], v[56:59]
    v_fmac_f32 v47, v88, v35
    v_mul_f32 v97, v45, v45
    v_mfma_f32_16x16x32_bf16 v[60:63], a[192:195], v[80:83], v[60:63]
    s_waitcnt vmcnt(6)
    s_barrier
    s_lshl_b32 s72, s64, 11
    s_lshl_b32 s73, s65, 7
    s_add_u32 s72, s72, s73
    s_add_u32 s72, s72, 167936
    buffer_store_dwordx2 v[8:9], v5, s[36:39], s72 offen sc1
    v_mfma_f32_16x16x32_bf16 v[52:55], a[36:39], v[84:87], v[52:55]
    ds_read_b128 v[76:79], v108 offset:33792
    v_mul_f32 v47, v45, v47
    v_mfma_f32_16x16x32_bf16 v[56:59], a[116:119], v[84:87], v[56:59]
    s_add_u32 s23, s84, 0
    s_waitcnt vmcnt(5)
    v_cmp_ne_u64 vcc, s[70:71], v[104:105]
    s_cbranch_vccz L_pd6
    s_mov_b32 s95, 100000
L_pl6:
    buffer_load_dwordx2 v[104:105], v6, s[36:39], s23 offen sc1
    s_waitcnt vmcnt(0)
    v_cmp_ne_u64 vcc, s[70:71], v[104:105]
    s_cbranch_vccz L_pd6
    s_sub_u32 s95, s95, 1
    s_cbranch_scc0 L_pl6
L_pd6:
    s_add_u32 s60, s85, 4096
    s_add_u32 s60, s36, s60
    s_addc_u32 s61, s37, 0
    global_load_dwordx4 a[0:3], v1, s[60:61] offset:-4096 sc1
    v_mfma_f32_16x16x32_bf16 v[60:63], a[196:199], v[84:87], v[60:63]
    s_waitcnt lgkmcnt(2)
    global_load_dwordx4 a[4:7], v1, s[60:61] offset:-3072 sc1
    v_fma_f32 v97, v97, v90, v89
    v_mfma_f32_16x16x32_bf16 v[52:55], a[40:43], v[64:67], v[52:55]
    ds_read_b128 v[80:83], v108 offset:34816
    v_mul_f32 v97, v97, v45
    v_mfma_f32_16x16x32_bf16 v[56:59], a[120:123], v[64:67], v[56:59]
    v_exp_f32 v97, v97
    v_mfma_f32_16x16x32_bf16 v[60:63], a[200:203], v[64:67], v[60:63]
    v_fma_f32 v96, v96, v91, v91
    v_rcp_f32 v96, v96
    v_mfma_f32_16x16x32_bf16 v[52:55], a[44:47], v[68:71], v[52:55]
    ds_read_b128 v[84:87], v108 offset:35840
    v_fma_f32 v97, v97, v91, v91
    v_mfma_f32_16x16x32_bf16 v[56:59], a[124:127], v[68:71], v[56:59]
    v_rcp_f32 v97, v97
    v_mfma_f32_16x16x32_bf16 v[60:63], a[204:207], v[68:71], v[60:63]
    s_waitcnt lgkmcnt(2)
    global_load_dwordx4 a[8:11], v1, s[60:61] offset:-2048 sc1
    v_mul_f32 v46, v46, v96
    v_mfma_f32_16x16x32_bf16 v[52:55], a[48:51], v[72:75], v[52:55]
    ds_read_b128 v[64:67], v108 offset:36864
    global_load_dwordx4 a[12:15], v1, s[60:61] offset:-1024 sc1
    v_mfma_f32_16x16x32_bf16 v[56:59], a[128:131], v[72:75], v[56:59]
    v_mul_f32 v47, v47, v97
    v_cvt_pk_bf16_f32 v93, v46, v47
    v_mfma_f32_16x16x32_bf16 v[60:63], a[208:211], v[72:75], v[60:63]
    s_nop 0
    v_permlane32_swap_b32 v93, v92
    v_mfma_f32_16x16x32_bf16 v[52:55], a[52:55], v[76:79], v[52:55]
    ds_read_b128 v[68:71], v108 offset:37888
    v_fmac_f32 v48, v88, v36
    v_mfma_f32_16x16x32_bf16 v[56:59], a[132:135], v[76:79], v[56:59]
    v_fmac_f32 v50, v88, v38
    v_mul_f32 v96, v48, v48
    v_mfma_f32_16x16x32_bf16 v[60:63], a[212:215], v[76:79], v[60:63]
    s_waitcnt lgkmcnt(2)
    v_mul_f32 v50, v48, v50
    v_fma_f32 v96, v96, v90, v89
    v_mfma_f32_16x16x32_bf16 v[52:55], a[56:59], v[80:83], v[52:55]
    ds_read_b128 v[72:75], v108 offset:38912
    v_mul_f32 v96, v96, v48
    v_mfma_f32_16x16x32_bf16 v[56:59], a[136:139], v[80:83], v[56:59]
    v_exp_f32 v96, v96
    v_mfma_f32_16x16x32_bf16 v[60:63], a[216:219], v[80:83], v[60:63]
    global_load_dwordx4 a[16:19], v1, s[60:61] offset:0 sc1
    global_load_dwordx4 a[20:23], v1, s[60:61] offset:1024 sc1
    v_mfma_f32_16x16x32_bf16 v[52:55], a[60:63], v[84:87], v[52:55]
    ds_read_b128 v[76:79], v108 offset:39936
    v_fmac_f32 v49, v88, v37
    v_mfma_f32_16x16x32_bf16 v[56:59], a[140:143], v[84:87], v[56:59]
    v_fmac_f32 v51, v88, v39
    v_mul_f32 v97, v49, v49
    v_mfma_f32_16x16x32_bf16 v[60:63], a[220:223], v[84:87], v[60:63]
    s_waitcnt lgkmcnt(2)
    global_load_dwordx4 a[24:27], v1, s[60:61] offset:2048 sc1
    v_mul_f32 v51, v49, v51
    v_mfma_f32_16x16x32_bf16 v[52:55], a[64:67], v[64:67], v[52:55]
    v_fma_f32 v97, v97, v90, v89
    v_mul_f32 v97, v97, v49
    v_mfma_f32_16x16x32_bf16 v[56:59], a[144:147], v[64:67], v[56:59]
    v_exp_f32 v97, v97
    v_mfma_f32_16x16x32_bf16 v[60:63], a[224:227], v[64:67], v[60:63]
    v_fma_f32 v96, v96, v91, v91
    v_rcp_f32 v96, v96
    v_mfma_f32_16x16x32_bf16 v[52:55], a[68:71], v[68:71], v[52:55]
    global_load_dwordx4 a[28:31], v1, s[60:61] offset:3072 sc1
    v_fma_f32 v97, v97, v91, v91
    v_mfma_f32_16x16x32_bf16 v[56:59], a[148:151], v[68:71], v[56:59]
    v_rcp_f32 v97, v97
    v_mfma_f32_16x16x32_bf16 v[60:63], a[228:231], v[68:71], v[60:63]
    s_waitcnt lgkmcnt(0)
    v_mul_f32 v50, v50, v96
    v_mul_f32 v51, v51, v97
    v_cvt_pk_bf16_f32 v94, v50, v51
    v_mfma_f32_16x16x32_bf16 v[52:55], a[72:75], v[72:75], v[52:55]
    s_add_u32 s21, s91, 294912
    v_permlane32_swap_b32 v94, v95
    v_mfma_f32_16x16x32_bf16 v[56:59], a[152:155], v[72:75], v[56:59]
    buffer_store_dwordx4 v[92:95], v110, s[36:39], s21 offen sc1
    v_mfma_f32_16x16x32_bf16 v[60:63], a[232:235], v[72:75], v[60:63]
    v_mfma_f32_16x16x32_bf16 v[52:55], a[76:79], v[76:79], v[52:55]
    v_mfma_f32_16x16x32_bf16 v[56:59], a[156:159], v[76:79], v[56:59]
    s_add_u32 s60, s85, 12288
    v_mfma_f32_16x16x32_bf16 v[60:63], a[236:239], v[76:79], v[60:63]
    s_add_u32 s60, s36, s60
    s_addc_u32 s61, s37, 0
    global_load_dwordx4 a[32:35], v1, s[60:61] offset:-4096 sc1
    ds_read_b128 v[88:91], v109 offset:1792
    v_add_u32 v11, s80, v1
    s_waitcnt vmcnt(11)
    s_waitcnt vmcnt(9)
    v_mfma_f32_16x16x32_bf16 v[64:67], v[112:115], a[0:3], 0
    s_add_u32 s60, s85, 12288
    s_waitcnt lgkmcnt(0)
    v_fmac_f32 v52, v88, v28
    v_fmac_f32 v54, v88, v30
    v_mfma_f32_16x16x32_bf16 v[68:71], v[116:119], a[0:3], 0
    s_add_u32 s60, s36, s60
    s_addc_u32 s61, s37, 0
    v_mul_f32 v96, v52, v52
    v_mfma_f32_16x16x32_bf16 v[72:75], v[120:123], a[0:3], 0
    global_load_dwordx4 a[36:39], v1, s[60:61] offset:-3072 sc1
    v_mul_f32 v54, v52, v54
    v_mfma_f32_16x16x32_bf16 v[76:79], v[124:127], a[0:3], 0
    v_fma_f32 v96, v96, v90, v89
    v_mul_f32 v96, v96, v52
    v_mfma_f32_16x16x32_bf16 v[80:83], v[128:131], a[0:3], 0
    v_exp_f32 v96, v96
    s_waitcnt vmcnt(9)
    v_mfma_f32_16x16x32_bf16 v[64:67], v[132:135], a[4:7], v[64:67]
    global_load_dwordx4 a[40:43], v1, s[60:61] offset:-2048 sc1
    v_fmac_f32 v53, v88, v29
    v_mfma_f32_16x16x32_bf16 v[68:71], v[136:139], a[4:7], v[68:71]
    global_load_dwordx4 a[44:47], v1, s[60:61] offset:-1024 sc1
    v_fmac_f32 v55, v88, v31
    v_mfma_f32_16x16x32_bf16 v[72:75], v[140:143], a[4:7], v[72:75]
    v_mul_f32 v97, v53, v53
    v_mul_f32 v55, v53, v55
    v_mfma_f32_16x16x32_bf16 v[76:79], v[144:147], a[4:7], v[76:79]
    v_fma_f32 v97, v97, v90, v89
    v_mul_f32 v97, v97, v53
    v_mfma_f32_16x16x32_bf16 v[80:83], v[148:151], a[4:7], v[80:83]
    s_add_u32 s60, s85, 102400
    v_exp_f32 v97, v97
    s_waitcnt vmcnt(10)
    v_mfma_f32_16x16x32_bf16 v[64:67], v[152:155], a[8:11], v[64:67]
    s_add_u32 s60, s36, s60
    s_addc_u32 s61, s37, 0
    v_fma_f32 v96, v96, v91, v91
    v_mfma_f32_16x16x32_bf16 v[68:71], v[156:159], a[8:11], v[68:71]
    v_rcp_f32 v96, v96
    v_mfma_f32_16x16x32_bf16 v[72:75], v[160:163], a[8:11], v[72:75]
    global_load_dwordx4 a[80:83], v1, s[60:61] offset:-4096 sc1
    v_fma_f32 v97, v97, v91, v91
    v_mfma_f32_16x16x32_bf16 v[76:79], v[164:167], a[8:11], v[76:79]
    v_rcp_f32 v97, v97
    v_mfma_f32_16x16x32_bf16 v[80:83], v[168:171], a[8:11], v[80:83]
    v_mul_f32 v54, v54, v96
    v_mul_f32 v55, v55, v97
    v_cvt_pk_bf16_f32 v92, v54, v55
    s_waitcnt vmcnt(10)
    v_mfma_f32_16x16x32_bf16 v[64:67], v[172:175], a[12:15], v[64:67]
    v_permlane16_swap_b32 v92, v95
    v_mfma_f32_16x16x32_bf16 v[68:71], v[176:179], a[12:15], v[68:71]
    v_fmac_f32 v56, v88, v32
    v_fmac_f32 v58, v88, v34
    v_mfma_f32_16x16x32_bf16 v[72:75], v[180:183], a[12:15], v[72:75]
    v_mul_f32 v96, v56, v56
    v_mul_f32 v58, v56, v58
    v_mfma_f32_16x16x32_bf16 v[76:79], v[184:187], a[12:15], v[76:79]
    v_fma_f32 v96, v96, v90, v89
    v_mul_f32 v96, v96, v56
    v_mfma_f32_16x16x32_bf16 v[80:83], v[188:191], a[12:15], v[80:83]
    v_exp_f32 v96, v96
    s_waitcnt vmcnt(9)
    v_mfma_f32_16x16x32_bf16 v[64:67], v[192:195], a[16:19], v[64:67]
    v_fmac_f32 v57, v88, v33
    v_fmac_f32 v59, v88, v35
    v_mfma_f32_16x16x32_bf16 v[68:71], v[196:199], a[16:19], v[68:71]
    global_load_dwordx4 a[84:87], v1, s[60:61] offset:-3072 sc1
    v_mul_f32 v97, v57, v57
    v_mul_f32 v59, v57, v59
    v_fma_f32 v97, v97, v90, v89
    v_mfma_f32_16x16x32_bf16 v[72:75], v[200:203], a[16:19], v[72:75]
    v_mul_f32 v97, v97, v57
    v_exp_f32 v97, v97
    v_fma_f32 v96, v96, v91, v91
    v_mfma_f32_16x16x32_bf16 v[76:79], v[204:207], a[16:19], v[76:79]
    v_rcp_f32 v96, v96
    v_fma_f32 v97, v97, v91, v91
    v_rcp_f32 v97, v97
    v_mfma_f32_16x16x32_bf16 v[80:83], v[208:211], a[16:19], v[80:83]
    v_mul_f32 v58, v58, v96
    v_mul_f32 v59, v59, v97
    v_cvt_pk_bf16_f32 v93, v58, v59
    s_waitcnt vmcnt(9)
    v_mfma_f32_16x16x32_bf16 v[64:67], v[212:215], a[20:23], v[64:67]
    v_permlane32_swap_b32 v93, v92
    v_fmac_f32 v60, v88, v36
    v_fmac_f32 v62, v88, v38
    v_mul_f32 v96, v60, v60
    v_mul_f32 v62, v60, v62
    v_fma_f32 v96, v96, v90, v89
    v_mul_f32 v96, v96, v60
    v_exp_f32 v96, v96
    v_fmac_f32 v61, v88, v37
    v_fmac_f32 v63, v88, v39
    v_mul_f32 v97, v61, v61
    v_mul_f32 v63, v61, v63
    v_fma_f32 v97, v97, v90, v89
    v_mul_f32 v97, v97, v61
    v_exp_f32 v97, v97
    v_fma_f32 v96, v96, v91, v91
    v_rcp_f32 v96, v96
    v_fma_f32 v97, v97, v91, v91
    v_rcp_f32 v97, v97
    v_mul_f32 v62, v62, v96
    v_mul_f32 v63, v63, v97
    v_cvt_pk_bf16_f32 v94, v62, v63
    s_add_u32 s21, s91, 344064
    s_nop 0
    v_permlane32_swap_b32 v94, v95
    buffer_store_dwordx4 v[92:95], v110, s[36:39], s21 offen sc1
    v_mfma_f32_16x16x32_bf16 v[68:71], v[216:219], a[20:23], v[68:71]
    global_load_dwordx4 a[88:91], v1, s[60:61] offset:-2048 sc1
    global_load_dwordx4 a[92:95], v1, s[60:61] offset:-1024 sc1
    v_mfma_f32_16x16x32_bf16 v[72:75], v[220:223], a[20:23], v[72:75]
    ds_read_b128 a[48:51], v11 offset:2048
    ds_read_b128 a[52:55], v11 offset:3072
    v_mfma_f32_16x16x32_bf16 v[76:79], v[224:227], a[20:23], v[76:79]
    ds_read_b128 a[56:59], v11 offset:4096
    ds_read_b128 a[60:63], v11 offset:5120
    v_mfma_f32_16x16x32_bf16 v[80:83], v[228:231], a[20:23], v[80:83]
    ds_read_b128 a[64:67], v11 offset:6144
    ds_read_b128 a[68:71], v11 offset:7168
    s_waitcnt vmcnt(11)
    v_mfma_f32_16x16x32_bf16 v[64:67], v[232:235], a[24:27], v[64:67]
    ds_read_b128 a[72:75], v11 offset:8192
    global_load_dwordx4 a[96:99], v1, s[60:61] offset:0 sc1
    v_mfma_f32_16x16x32_bf16 v[68:71], v[236:239], a[24:27], v[68:71]
    ds_read_b128 a[76:79], v11 offset:9216
    ds_read_b128 a[128:131], v11 offset:10240
    v_mfma_f32_16x16x32_bf16 v[72:75], v[240:243], a[24:27], v[72:75]
    ds_read_b128 a[132:135], v11 offset:11264
    ds_read_b128 a[136:139], v11 offset:12288
    v_mfma_f32_16x16x32_bf16 v[76:79], v[244:247], a[24:27], v[76:79]
    ds_read_b128 a[140:143], v11 offset:13312
    ds_read_b128 a[144:147], v11 offset:14336
    v_mfma_f32_16x16x32_bf16 v[80:83], v[248:251], a[24:27], v[80:83]
    ds_read_b128 a[148:151], v11 offset:15360
    global_load_dwordx4 a[100:103], v1, s[60:61] offset:1024 sc1
    s_waitcnt vmcnt(12)
    v_mfma_f32_16x16x32_bf16 v[64:67], v[252:255], a[28:31], v[64:67]
    ds_read_b128 a[152:155], v11 offset:16384
    ds_read_b128 a[156:159], v11 offset:17408
    s_waitcnt lgkmcnt(12)
    v_mfma_f32_16x16x32_bf16 v[68:71], a[48:51], a[28:31], v[68:71]
    ds_read_b128 a[208:211], v11 offset:18432
    ds_read_b128 a[212:215], v11 offset:19456
    v_mfma_f32_16x16x32_bf16 v[72:75], a[52:55], a[28:31], v[72:75]
    ds_read_b128 a[216:219], v11 offset:20480
    ds_read_b128 a[220:223], v11 offset:21504
    v_mfma_f32_16x16x32_bf16 v[76:79], a[56:59], a[28:31], v[76:79]
    ds_read_b128 a[224:227], v11 offset:22528
    ds_read_b128 a[228:231], v11 offset:23552
    v_mfma_f32_16x16x32_bf16 v[80:83], a[60:63], a[28:31], v[80:83]
    ds_read_b128 a[232:235], v11 offset:24576
    ds_read_b128 a[236:239], v11 offset:25600
    s_waitcnt vmcnt(10) lgkmcnt(13)
    v_mfma_f32_16x16x32_bf16 v[64:67], a[64:67], a[32:35], v[64:67]
    s_mul_i32 s74, s67, 5120
    v_add_u32 v84, s74, v111
    s_mul_i32 s74, s67, 20480
    v_add_u32 v85, s74, v111
    v_mfma_f32_16x16x32_bf16 v[68:71], a[68:71], a[32:35], v[68:71]
    v_mfma_f32_16x16x32_bf16 v[72:75], a[72:75], a[32:35], v[72:75]
    v_mfma_f32_16x16x32_bf16 v[76:79], a[76:79], a[32:35], v[76:79]
    s_add_u32 s23, s84, 32768
    v_mfma_f32_16x16x32_bf16 v[80:83], a[128:131], a[32:35], v[80:83]
    buffer_load_dwordx2 v[106:107], v6, s[36:39], s23 offen sc1
    s_waitcnt vmcnt(10)
    v_mfma_f32_16x16x32_bf16 v[64:67], a[132:135], a[36:39], v[64:67]
    v_mfma_f32_16x16x32_bf16 v[68:71], a[136:139], a[36:39], v[68:71]
    s_waitcnt lgkmcnt(0)
    v_mfma_f32_16x16x32_bf16 v[72:75], a[140:143], a[36:39], v[72:75]
    v_mfma_f32_16x16x32_bf16 v[76:79], a[144:147], a[36:39], v[76:79]
    s_add_u32 s60, s85, 102400
    v_mfma_f32_16x16x32_bf16 v[80:83], a[148:151], a[36:39], v[80:83]
    s_add_u32 s60, s36, s60
    s_addc_u32 s61, s37, 0
    global_load_dwordx4 a[104:107], v1, s[60:61] offset:2048 sc1
    s_waitcnt vmcnt(10)
    v_mfma_f32_16x16x32_bf16 v[64:67], a[152:155], a[40:43], v[64:67]
    v_mfma_f32_16x16x32_bf16 v[68:71], a[156:159], a[40:43], v[68:71]
    v_mfma_f32_16x16x32_bf16 v[72:75], a[208:211], a[40:43], v[72:75]
    v_mfma_f32_16x16x32_bf16 v[76:79], a[212:215], a[40:43], v[76:79]
    v_mfma_f32_16x16x32_bf16 v[80:83], a[216:219], a[40:43], v[80:83]
    global_load_dwordx4 a[108:111], v1, s[60:61] offset:3072 sc1
    s_waitcnt vmcnt(10)
    v_mfma_f32_16x16x32_bf16 v[64:67], a[220:223], a[44:47], v[64:67]
    v_mfma_f32_16x16x32_bf16 v[68:71], a[224:227], a[44:47], v[68:71]
    s_waitcnt vmcnt(7)
    s_barrier
    s_lshl_b32 s72, s64, 11
    s_lshl_b32 s73, s65, 7
    s_add_u32 s72, s72, s73
    s_add_u32 s72, s72, 200704
    buffer_store_dwordx2 v[8:9], v5, s[36:39], s72 offen sc1
    v_mfma_f32_16x16x32_bf16 v[72:75], a[228:231], a[44:47], v[72:75]
    s_add_u32 s60, s85, 110592
    v_mfma_f32_16x16x32_bf16 v[76:79], a[232:235], a[44:47], v[76:79]
    s_add_u32 s60, s36, s60
    s_addc_u32 s61, s37, 0
    global_load_dwordx4 a[112:115], v1, s[60:61] offset:-4096 sc1
    v_mfma_f32_16x16x32_bf16 v[80:83], a[236:239], a[44:47], v[80:83]
    v_mfma_f32_16x16x32_bf16 v[40:43], v[112:115], a[80:83], 0
    v_mfma_f32_16x16x32_bf16 v[44:47], v[116:119], a[80:83], 0
    v_mfma_f32_16x16x32_bf16 v[48:51], v[120:123], a[80:83], 0
    v_mfma_f32_16x16x32_bf16 v[52:55], v[124:127], a[80:83], 0
    global_load_dwordx4 a[116:119], v1, s[60:61] offset:-3072 sc1
    v_mfma_f32_16x16x32_bf16 v[56:59], v[128:131], a[80:83], 0
    v_mfma_f32_16x16x32_bf16 v[40:43], v[132:135], a[84:87], v[40:43]
    v_mfma_f32_16x16x32_bf16 v[44:47], v[136:139], a[84:87], v[44:47]
    v_mfma_f32_16x16x32_bf16 v[48:51], v[140:143], a[84:87], v[48:51]
    ds_write_b64 v84, v[64:65] offset:0
    v_mfma_f32_16x16x32_bf16 v[52:55], v[144:147], a[84:87], v[52:55]
    global_load_dwordx4 a[120:123], v1, s[60:61] offset:-2048 sc1
    v_mfma_f32_16x16x32_bf16 v[56:59], v[148:151], a[84:87], v[56:59]
    s_waitcnt vmcnt(10)
    v_mfma_f32_16x16x32_bf16 v[40:43], v[152:155], a[88:91], v[40:43]
    v_mfma_f32_16x16x32_bf16 v[44:47], v[156:159], a[88:91], v[44:47]
    ds_write_b64 v84, v[66:67] offset:512
    v_mfma_f32_16x16x32_bf16 v[48:51], v[160:163], a[88:91], v[48:51]
    global_load_dwordx4 a[124:127], v1, s[60:61] offset:-1024 sc1
    v_mfma_f32_16x16x32_bf16 v[52:55], v[164:167], a[88:91], v[52:55]
    v_mfma_f32_16x16x32_bf16 v[56:59], v[168:171], a[88:91], v[56:59]
    s_waitcnt vmcnt(10)
    v_mfma_f32_16x16x32_bf16 v[40:43], v[172:175], a[92:95], v[40:43]
    v_mfma_f32_16x16x32_bf16 v[44:47], v[176:179], a[92:95], v[44:47]
    ds_write_b64 v84, v[68:69] offset:1024
    v_mfma_f32_16x16x32_bf16 v[48:51], v[180:183], a[92:95], v[48:51]
    s_add_u32 s23, s84, 32768
    s_waitcnt vmcnt(7)
    v_cmp_ne_u64 vcc, s[70:71], v[106:107]
    s_cbranch_vccz L_pd7
    s_mov_b32 s95, 100000
L_pl7:
    buffer_load_dwordx2 v[106:107], v6, s[36:39], s23 offen sc1
    s_waitcnt vmcnt(0)
    v_cmp_ne_u64 vcc, s[70:71], v[106:107]
    s_cbranch_vccz L_pd7
    s_sub_u32 s95, s95, 1
    s_cbranch_scc0 L_pl7
L_pd7:
    s_add_u32 s60, s85, 200704
    s_add_u32 s60, s36, s60
    s_addc_u32 s61, s37, 0
    global_load_dwordx4 a[160:163], v1, s[60:61] offset:-4096 sc1
    v_mfma_f32_16x16x32_bf16 v[52:55], v[184:187], a[92:95], v[52:55]
    v_mfma_f32_16x16x32_bf16 v[56:59], v[188:191], a[92:95], v[56:59]
    v_mfma_f32_16x16x32_bf16 v[40:43], v[192:195], a[96:99], v[40:43]
    ds_write_b64 v84, v[70:71] offset:1536
    v_mfma_f32_16x16x32_bf16 v[44:47], v[196:199], a[96:99], v[44:47]
    global_load_dwordx4 a[164:167], v1, s[60:61] offset:-3072 sc1
    v_mfma_f32_16x16x32_bf16 v[48:51], v[200:203], a[96:99], v[48:51]
    v_mfma_f32_16x16x32_bf16 v[52:55], v[204:207], a[96:99], v[52:55]
    v_mfma_f32_16x16x32_bf16 v[56:59], v[208:211], a[96:99], v[56:59]
    v_mfma_f32_16x16x32_bf16 v[40:43], v[212:215], a[100:103], v[40:43]
    ds_write_b64 v84, v[72:73] offset:2048
    v_mfma_f32_16x16x32_bf16 v[44:47], v[216:219], a[100:103], v[44:47]
    global_load_dwordx4 a[168:171], v1, s[60:61] offset:-2048 sc1
    v_mfma_f32_16x16x32_bf16 v[48:51], v[220:223], a[100:103], v[48:51]
    v_mfma_f32_16x16x32_bf16 v[52:55], v[224:227], a[100:103], v[52:55]
    v_mfma_f32_16x16x32_bf16 v[56:59], v[228:231], a[100:103], v[56:59]
    s_waitcnt vmcnt(9)
    v_mfma_f32_16x16x32_bf16 v[40:43], v[232:235], a[104:107], v[40:43]
    ds_write_b64 v84, v[74:75] offset:2560
    v_mfma_f32_16x16x32_bf16 v[44:47], v[236:239], a[104:107], v[44:47]
    global_load_dwordx4 a[172:175], v1, s[60:61] offset:-1024 sc1
    v_mfma_f32_16x16x32_bf16 v[48:51], v[240:243], a[104:107], v[48:51]
    v_mfma_f32_16x16x32_bf16 v[52:55], v[244:247], a[104:107], v[52:55]
    v_mfma_f32_16x16x32_bf16 v[56:59], v[248:251], a[104:107], v[56:59]
    ds_write_b64 v84, v[76:77] offset:3072
    s_waitcnt vmcnt(9)
    v_mfma_f32_16x16x32_bf16 v[40:43], v[252:255], a[108:111], v[40:43]
    global_load_dwordx4 a[176:179], v1, s[60:61] offset:0 sc1
    v_mfma_f32_16x16x32_bf16 v[44:47], a[48:51], a[108:111], v[44:47]
    v_mfma_f32_16x16x32_bf16 v[48:51], a[52:55], a[108:111], v[48:51]
    v_mfma_f32_16x16x32_bf16 v[52:55], a[56:59], a[108:111], v[52:55]
    v_mfma_f32_16x16x32_bf16 v[56:59], a[60:63], a[108:111], v[56:59]
    ds_write_b64 v84, v[78:79] offset:3584
    s_waitcnt vmcnt(8)
    v_mfma_f32_16x16x32_bf16 v[40:43], a[64:67], a[112:115], v[40:43]
    global_load_dwordx4 a[180:183], v1, s[60:61] offset:1024 sc1
    v_mfma_f32_16x16x32_bf16 v[44:47], a[68:71], a[112:115], v[44:47]
    v_mfma_f32_16x16x32_bf16 v[48:51], a[72:75], a[112:115], v[48:51]
    v_mfma_f32_16x16x32_bf16 v[52:55], a[76:79], a[112:115], v[52:55]
    ds_write_b64 v84, v[80:81] offset:4096
    v_mfma_f32_16x16x32_bf16 v[56:59], a[128:131], a[112:115], v[56:59]
    global_load_dwordx4 a[184:187], v1, s[60:61] offset:2048 sc1
    s_waitcnt vmcnt(9)
    v_mfma_f32_16x16x32_bf16 v[40:43], a[132:135], a[116:119], v[40:43]
    v_mfma_f32_16x16x32_bf16 v[44:47], a[136:139], a[116:119], v[44:47]
    v_mfma_f32_16x16x32_bf16 v[48:51], a[140:143], a[116:119], v[48:51]
    v_mfma_f32_16x16x32_bf16 v[52:55], a[144:147], a[116:119], v[52:55]
    ds_write_b64 v84, v[82:83] offset:4608
    v_mfma_f32_16x16x32_bf16 v[56:59], a[148:151], a[116:119], v[56:59]
    global_load_dwordx4 a[188:191], v1, s[60:61] offset:3072 sc1
    s_waitcnt vmcnt(9)
    v_mfma_f32_16x16x32_bf16 v[40:43], a[152:155], a[120:123], v[40:43]
    v_mfma_f32_16x16x32_bf16 v[44:47], a[156:159], a[120:123], v[44:47]
    v_mfma_f32_16x16x32_bf16 v[48:51], a[208:211], a[120:123], v[48:51]
    v_mfma_f32_16x16x32_bf16 v[52:55], a[212:215], a[120:123], v[52:55]
    s_add_u32 s60, s85, 208896
    v_mfma_f32_16x16x32_bf16 v[56:59], a[216:219], a[120:123], v[56:59]
    s_add_u32 s60, s36, s60
    s_addc_u32 s61, s37, 0
    global_load_dwordx4 a[192:195], v1, s[60:61] offset:-4096 sc1
    s_waitcnt vmcnt(9)
    v_mfma_f32_16x16x32_bf16 v[40:43], a[220:223], a[124:127], v[40:43]
    v_mfma_f32_16x16x32_bf16 v[44:47], a[224:227], a[124:127], v[44:47]
    v_mfma_f32_16x16x32_bf16 v[48:51], a[228:231], a[124:127], v[48:51]
    v_mfma_f32_16x16x32_bf16 v[52:55], a[232:235], a[124:127], v[52:55]
    global_load_dwordx4 a[196:199], v1, s[60:61] offset:-3072 sc1
    v_mfma_f32_16x16x32_bf16 v[56:59], a[236:239], a[124:127], v[56:59]
    s_waitcnt vmcnt(9)
    v_mfma_f32_16x16x32_bf16 v[64:67], v[112:115], a[160:163], 0
    v_mfma_f32_16x16x32_bf16 v[68:71], v[116:119], a[160:163], 0
    s_add_u32 s60, s85, 208896
    v_mfma_f32_16x16x32_bf16 v[72:75], v[120:123], a[160:163], 0
    s_add_u32 s60, s36, s60
    s_addc_u32 s61, s37, 0
    global_load_dwordx4 a[200:203], v1, s[60:61] offset:-2048 sc1
    v_mfma_f32_16x16x32_bf16 v[76:79], v[124:127], a[160:163], 0
    v_mfma_f32_16x16x32_bf16 v[80:83], v[128:131], a[160:163], 0
    global_load_dwordx4 a[204:207], v1, s[60:61] offset:-1024 sc1
    s_waitcnt vmcnt(10)
    v_mfma_f32_16x16x32_bf16 v[64:67], v[132:135], a[164:167], v[64:67]
    v_mfma_f32_16x16x32_bf16 v[68:71], v[136:139], a[164:167], v[68:71]
    s_add_u32 s23, s84, 65536
    ds_write_b64 v84, v[40:41] offset:20480
    v_mfma_f32_16x16x32_bf16 v[72:75], v[140:143], a[164:167], v[72:75]
    buffer_load_dwordx2 v[104:105], v6, s[36:39], s23 offen sc1
    v_mfma_f32_16x16x32_bf16 v[76:79], v[144:147], a[164:167], v[76:79]
    v_mfma_f32_16x16x32_bf16 v[80:83], v[148:151], a[164:167], v[80:83]
    s_waitcnt vmcnt(10)
    v_mfma_f32_16x16x32_bf16 v[64:67], v[152:155], a[168:171], v[64:67]
    v_mfma_f32_16x16x32_bf16 v[68:71], v[156:159], a[168:171], v[68:71]
    ds_write_b64 v84, v[42:43] offset:20992
    v_mfma_f32_16x16x32_bf16 v[72:75], v[160:163], a[168:171], v[72:75]
    v_mfma_f32_16x16x32_bf16 v[76:79], v[164:167], a[168:171], v[76:79]
    v_mfma_f32_16x16x32_bf16 v[80:83], v[168:171], a[168:171], v[80:83]
    s_waitcnt vmcnt(9)
    v_mfma_f32_16x16x32_bf16 v[64:67], v[172:175], a[172:175], v[64:67]
    v_mfma_f32_16x16x32_bf16 v[68:71], v[176:179], a[172:175], v[68:71]
    ds_write_b64 v84, v[44:45] offset:21504
    v_mfma_f32_16x16x32_bf16 v[72:75], v[180:183], a[172:175], v[72:75]
    v_mfma_f32_16x16x32_bf16 v[76:79], v[184:187], a[172:175], v[76:79]
    v_mfma_f32_16x16x32_bf16 v[80:83], v[188:191], a[172:175], v[80:83]
    s_waitcnt vmcnt(8)
    v_mfma_f32_16x16x32_bf16 v[64:67], v[192:195], a[176:179], v[64:67]
    v_mfma_f32_16x16x32_bf16 v[68:71], v[196:199], a[176:179], v[68:71]
    ds_write_b64 v84, v[46:47] offset:22016
    v_mfma_f32_16x16x32_bf16 v[72:75], v[200:203], a[176:179], v[72:75]
    v_mfma_f32_16x16x32_bf16 v[76:79], v[204:207], a[176:179], v[76:79]
    v_mfma_f32_16x16x32_bf16 v[80:83], v[208:211], a[176:179], v[80:83]
    s_waitcnt vmcnt(7)
    v_mfma_f32_16x16x32_bf16 v[64:67], v[212:215], a[180:183], v[64:67]
    ds_write_b64 v84, v[48:49] offset:22528
    v_mfma_f32_16x16x32_bf16 v[68:71], v[216:219], a[180:183], v[68:71]
    v_mfma_f32_16x16x32_bf16 v[72:75], v[220:223], a[180:183], v[72:75]
    v_mfma_f32_16x16x32_bf16 v[76:79], v[224:227], a[180:183], v[76:79]
    v_mfma_f32_16x16x32_bf16 v[80:83], v[228:231], a[180:183], v[80:83]
    s_waitcnt vmcnt(6)
    v_mfma_f32_16x16x32_bf16 v[64:67], v[232:235], a[184:187], v[64:67]
    ds_write_b64 v84, v[50:51] offset:23040
    v_mfma_f32_16x16x32_bf16 v[68:71], v[236:239], a[184:187], v[68:71]
    v_mfma_f32_16x16x32_bf16 v[72:75], v[240:243], a[184:187], v[72:75]
    s_add_u32 s23, s84, 65536
    s_waitcnt vmcnt(0)
    v_cmp_ne_u64 vcc, s[70:71], v[104:105]
    s_cbranch_vccz L_pd8
    s_mov_b32 s95, 100000
L_pl8:
    buffer_load_dwordx2 v[104:105], v6, s[36:39], s23 offen sc1
    s_waitcnt vmcnt(0)
    v_cmp_ne_u64 vcc, s[70:71], v[104:105]
    s_cbranch_vccz L_pd8
    s_sub_u32 s95, s95, 1
    s_cbranch_scc0 L_pl8
L_pd8:
    s_add_u32 s60, s85, 299008
    s_add_u32 s60, s36, s60
    s_addc_u32 s61, s37, 0
    global_load_dwordx4 a[0:3], v1, s[60:61] offset:-4096 sc1
    v_mfma_f32_16x16x32_bf16 v[76:79], v[244:247], a[184:187], v[76:79]
    v_mfma_f32_16x16x32_bf16 v[80:83], v[248:251], a[184:187], v[80:83]
    ds_write_b64 v84, v[52:53] offset:23552
    v_mfma_f32_16x16x32_bf16 v[64:67], v[252:255], a[188:191], v[64:67]
    v_mfma_f32_16x16x32_bf16 v[68:71], a[48:51], a[188:191], v[68:71]
    global_load_dwordx4 a[4:7], v1, s[60:61] offset:-3072 sc1
    v_mfma_f32_16x16x32_bf16 v[72:75], a[52:55], a[188:191], v[72:75]
    v_mfma_f32_16x16x32_bf16 v[76:79], a[56:59], a[188:191], v[76:79]
    v_mfma_f32_16x16x32_bf16 v[80:83], a[60:63], a[188:191], v[80:83]
    ds_write_b64 v84, v[54:55] offset:24064
    v_mfma_f32_16x16x32_bf16 v[64:67], a[64:67], a[192:195], v[64:67]
    global_load_dwordx4 a[8:11], v1, s[60:61] offset:-2048 sc1
    v_mfma_f32_16x16x32_bf16 v[68:71], a[68:71], a[192:195], v[68:71]
    s_mul_i32 s74, s67, 3072
    s_add_u32 s74, s74, 102400
    v_mul_u32_u24 v86, 160, v3
    v_mfma_f32_16x16x32_bf16 v[72:75], a[72:75], a[192:195], v[72:75]
    ds_write_b64 v84, v[56:57] offset:24576
    v_mfma_f32_16x16x32_bf16 v[76:79], a[76:79], a[192:195], v[76:79]
    ds_write_b64 v84, v[58:59] offset:25088
    v_mfma_f32_16x16x32_bf16 v[80:83], a[128:131], a[192:195], v[80:83]
    global_load_dwordx4 a[12:15], v1, s[60:61] offset:-1024 sc1
    v_mul_u32_u24 v11, 40, v2
    v_mfma_f32_16x16x32_bf16 v[64:67], a[132:135], a[196:199], v[64:67]
    global_load_dwordx4 a[16:19], v1, s[60:61] offset:0 sc1
    v_add3_u32 v86, v86, v11, s74
    v_mfma_f32_16x16x32_bf16 v[68:71], a[136:139], a[196:199], v[68:71]
    global_load_dwordx4 a[20:23], v1, s[60:61] offset:1024 sc1
    v_add_u32 v87, s74, v1
    v_mfma_f32_16x16x32_bf16 v[72:75], a[140:143], a[196:199], v[72:75]
    v_add_u32 v11, 0, v16
    v_mul_u32_u24 v12, 205, v11
    v_mfma_f32_16x16x32_bf16 v[76:79], a[144:147], a[196:199], v[76:79]
    v_lshrrev_b32 v12, 11, v12
    v_mul_u32_u24 v13, 10, v12
    v_mfma_f32_16x16x32_bf16 v[80:83], a[148:151], a[196:199], v[80:83]
    v_sub_u32 v13, v11, v13
    v_mul_u32_u24 v88, 1280, v12
    v_mfma_f32_16x16x32_bf16 v[64:67], a[152:155], a[200:203], v[64:67]
    global_load_dwordx4 a[24:27], v1, s[60:61] offset:2048 sc1
    v_lshl_add_u32 v88, v13, 4, v88
    v_mfma_f32_16x16x32_bf16 v[68:71], a[156:159], a[200:203], v[68:71]
    v_add_u32 v11, 64, v16
    v_mul_u32_u24 v12, 205, v11
    v_mfma_f32_16x16x32_bf16 v[72:75], a[208:211], a[200:203], v[72:75]
    v_lshrrev_b32 v12, 11, v12
    v_mul_u32_u24 v13, 10, v12
    v_mfma_f32_16x16x32_bf16 v[76:79], a[212:215], a[200:203], v[76:79]
    v_sub_u32 v13, v11, v13
    v_mul_u32_u24 v89, 1280, v12
    v_mfma_f32_16x16x32_bf16 v[80:83], a[216:219], a[200:203], v[80:83]
    v_lshl_add_u32 v89, v13, 4, v89
    v_add_u32 v11, 128, v16
    v_mfma_f32_16x16x32_bf16 v[64:67], a[220:223], a[204:207], v[64:67]
    v_mul_u32_u24 v12, 205, v11
    v_lshrrev_b32 v12, 11, v12
    v_mfma_f32_16x16x32_bf16 v[68:71], a[224:227], a[204:207], v[68:71]
    v_mul_u32_u24 v13, 10, v12
    v_sub_u32 v13, v11, v13
    v_mfma_f32_16x16x32_bf16 v[72:75], a[228:231], a[204:207], v[72:75]
    v_mul_u32_u24 v90, 1280, v12
    v_lshl_add_u32 v90, v13, 4, v90
    v_mfma_f32_16x16x32_bf16 v[76:79], a[232:235], a[204:207], v[76:79]
    v_mov_b32 v11, 1073741824
    v_cmp_gt_u32 s[76:77], 32, v16
    v_mfma_f32_16x16x32_bf16 v[80:83], a[236:239], a[204:207], v[80:83]
    global_load_dwordx4 a[28:31], v1, s[60:61] offset:3072 sc1
    v_cndmask_b32 v90, v11, v90, s[76:77]
    s_waitcnt vmcnt(7)
    v_mfma_f32_16x16x32_bf16 v[40:43], v[112:115], a[0:3], 0
    v_mfma_f32_16x16x32_bf16 v[44:47], v[116:119], a[0:3], 0
    s_add_u32 s60, s85, 307200
    v_mfma_f32_16x16x32_bf16 v[48:51], v[120:123], a[0:3], 0
    s_add_u32 s60, s36, s60
    s_addc_u32 s61, s37, 0
    global_load_dwordx4 a[32:35], v1, s[60:61] offset:-4096 sc1
    v_mfma_f32_16x16x32_bf16 v[52:55], v[124:127], a[0:3], 0
    v_mfma_f32_16x16x32_bf16 v[56:59], v[128:131], a[0:3], 0
    s_waitcnt vmcnt(7)
    v_mfma_f32_16x16x32_bf16 v[40:43], v[132:135], a[4:7], v[40:43]
    v_mfma_f32_16x16x32_bf16 v[44:47], v[136:139], a[4:7], v[44:47]
    global_load_dwordx4 a[36:39], v1, s[60:61] offset:-3072 sc1
    v_mfma_f32_16x16x32_bf16 v[48:51], v[140:143], a[4:7], v[48:51]
    ds_write_b64 v84, v[64:65] offset:40960
    v_mfma_f32_16x16x32_bf16 v[52:55], v[144:147], a[4:7], v[52:55]
    v_mfma_f32_16x16x32_bf16 v[56:59], v[148:151], a[4:7], v[56:59]
    s_waitcnt vmcnt(7)
    v_mfma_f32_16x16x32_bf16 v[40:43], v[152:155], a[8:11], v[40:43]
    global_load_dwordx4 a[40:43], v1, s[60:61] offset:-2048 sc1
    v_mfma_f32_16x16x32_bf16 v[44:47], v[156:159], a[8:11], v[44:47]
    ds_write_b64 v84, v[66:67] offset:41472
    v_mfma_f32_16x16x32_bf16 v[48:51], v[160:163], a[8:11], v[48:51]
    v_mfma_f32_16x16x32_bf16 v[52:55], v[164:167], a[8:11], v[52:55]
    v_mfma_f32_16x16x32_bf16 v[56:59], v[168:171], a[8:11], v[56:59]
    global_load_dwordx4 a[44:47], v1, s[60:61] offset:-1024 sc1
    s_waitcnt vmcnt(8)
    v_mfma_f32_16x16x32_bf16 v[40:43], v[172:175], a[12:15], v[40:43]
    v_mfma_f32_16x16x32_bf16 v[44:47], v[176:179], a[12:15], v[44:47]
    ds_write_b64 v84, v[68:69] offset:41984
    v_mfma_f32_16x16x32_bf16 v[48:51], v[180:183], a[12:15], v[48:51]
    v_mfma_f32_16x16x32_bf16 v[52:55], v[184:187], a[12:15], v[52:55]
    v_mfma_f32_16x16x32_bf16 v[56:59], v[188:191], a[12:15], v[56:59]
    s_waitcnt vmcnt(7)
    v_mfma_f32_16x16x32_bf16 v[40:43], v[192:195], a[16:19], v[40:43]
    v_mfma_f32_16x16x32_bf16 v[44:47], v[196:199], a[16:19], v[44:47]
    ds_write_b64 v84, v[70:71] offset:42496
    v_mfma_f32_16x16x32_bf16 v[48:51], v[200:203], a[16:19], v[48:51]
    v_mfma_f32_16x16x32_bf16 v[52:55], v[204:207], a[16:19], v[52:55]
    v_mfma_f32_16x16x32_bf16 v[56:59], v[208:211], a[16:19], v[56:59]
    s_waitcnt vmcnt(6)
    v_mfma_f32_16x16x32_bf16 v[40:43], v[212:215], a[20:23], v[40:43]
    ds_write_b64 v84, v[72:73] offset:43008
    v_mfma_f32_16x16x32_bf16 v[44:47], v[216:219], a[20:23], v[44:47]
    v_mfma_f32_16x16x32_bf16 v[48:51], v[220:223], a[20:23], v[48:51]
    v_mfma_f32_16x16x32_bf16 v[52:55], v[224:227], a[20:23], v[52:55]
    v_mfma_f32_16x16x32_bf16 v[56:59], v[228:231], a[20:23], v[56:59]
    s_waitcnt vmcnt(5)
    v_mfma_f32_16x16x32_bf16 v[40:43], v[232:235], a[24:27], v[40:43]
    ds_write_b64 v84, v[74:75] offset:43520
    v_mfma_f32_16x16x32_bf16 v[44:47], v[236:239], a[24:27], v[44:47]
    v_mfma_f32_16x16x32_bf16 v[48:51], v[240:243], a[24:27], v[48:51]
    v_mfma_f32_16x16x32_bf16 v[52:55], v[244:247], a[24:27], v[52:55]
    v_mfma_f32_16x16x32_bf16 v[56:59], v[248:251], a[24:27], v[56:59]
    ds_write_b64 v84, v[76:77] offset:44032
    s_waitcnt vmcnt(4)
    v_mfma_f32_16x16x32_bf16 v[40:43], v[252:255], a[28:31], v[40:43]
    v_mfma_f32_16x16x32_bf16 v[44:47], a[48:51], a[28:31], v[44:47]
    v_mfma_f32_16x16x32_bf16 v[48:51], a[52:55], a[28:31], v[48:51]
    v_mfma_f32_16x16x32_bf16 v[52:55], a[56:59], a[28:31], v[52:55]
    v_mfma_f32_16x16x32_bf16 v[56:59], a[60:63], a[28:31], v[56:59]
    ds_write_b64 v84, v[78:79] offset:44544
    s_waitcnt vmcnt(3)
    v_mfma_f32_16x16x32_bf16 v[40:43], a[64:67], a[32:35], v[40:43]
    v_mfma_f32_16x16x32_bf16 v[44:47], a[68:71], a[32:35], v[44:47]
    v_mfma_f32_16x16x32_bf16 v[48:51], a[72:75], a[32:35], v[48:51]
    v_mfma_f32_16x16x32_bf16 v[52:55], a[76:79], a[32:35], v[52:55]
    v_mfma_f32_16x16x32_bf16 v[56:59], a[128:131], a[32:35], v[56:59]
    ds_write_b64 v84, v[80:81] offset:45056
    s_waitcnt vmcnt(2)
    v_mfma_f32_16x16x32_bf16 v[40:43], a[132:135], a[36:39], v[40:43]
    v_mfma_f32_16x16x32_bf16 v[44:47], a[136:139], a[36:39], v[44:47]
    v_mfma_f32_16x16x32_bf16 v[48:51], a[140:143], a[36:39], v[48:51]
    v_mfma_f32_16x16x32_bf16 v[52:55], a[144:147], a[36:39], v[52:55]
    ds_write_b64 v84, v[82:83] offset:45568
    v_mfma_f32_16x16x32_bf16 v[56:59], a[148:151], a[36:39], v[56:59]
    s_waitcnt vmcnt(1)
    v_mfma_f32_16x16x32_bf16 v[40:43], a[152:155], a[40:43], v[40:43]
    v_mfma_f32_16x16x32_bf16 v[44:47], a[156:159], a[40:43], v[44:47]
    v_mfma_f32_16x16x32_bf16 v[48:51], a[208:211], a[40:43], v[48:51]
    v_mfma_f32_16x16x32_bf16 v[52:55], a[212:215], a[40:43], v[52:55]
    v_mfma_f32_16x16x32_bf16 v[56:59], a[216:219], a[40:43], v[56:59]
    s_waitcnt vmcnt(0)
    v_mfma_f32_16x16x32_bf16 v[40:43], a[220:223], a[44:47], v[40:43]
    v_mfma_f32_16x16x32_bf16 v[44:47], a[224:227], a[44:47], v[44:47]
    v_mfma_f32_16x16x32_bf16 v[48:51], a[228:231], a[44:47], v[48:51]
    v_mfma_f32_16x16x32_bf16 v[52:55], a[232:235], a[44:47], v[52:55]
    v_mfma_f32_16x16x32_bf16 v[56:59], a[236:239], a[44:47], v[56:59]
    v_add_u32 v84, 61440, v84
    s_nop 2
    ds_write_b64 v84, v[40:41] offset:0
    ds_write_b64 v84, v[42:43] offset:512
    ds_write_b64 v84, v[44:45] offset:1024
    ds_write_b64 v84, v[46:47] offset:1536
    ds_write_b64 v84, v[48:49] offset:2048
    ds_write_b64 v84, v[50:51] offset:2560
    ds_write_b64 v84, v[52:53] offset:3072
    ds_write_b64 v84, v[54:55] offset:3584
    ds_write_b64 v84, v[56:57] offset:4096
    ds_write_b64 v84, v[58:59] offset:4608
    s_waitcnt lgkmcnt(0)
    s_barrier
    ds_read_b64 v[112:113], v85 offset:0
    ds_read_b64 v[114:115], v85 offset:512
    ds_read_b64 v[116:117], v85 offset:1024
    ds_read_b64 v[118:119], v85 offset:1536
    ds_read_b64 v[120:121], v85 offset:2048
    ds_read_b64 v[122:123], v85 offset:2560
    ds_read_b64 v[124:125], v85 offset:3072
    ds_read_b64 v[126:127], v85 offset:3584
    ds_read_b64 v[128:129], v85 offset:4096
    ds_read_b64 v[130:131], v85 offset:4608
    ds_read_b64 v[132:133], v85 offset:5120
    ds_read_b64 v[134:135], v85 offset:5632
    ds_read_b64 v[136:137], v85 offset:6144
    ds_read_b64 v[138:139], v85 offset:6656
    ds_read_b64 v[140:141], v85 offset:7168
    ds_read_b64 v[142:143], v85 offset:7680
    ds_read_b64 v[144:145], v85 offset:8192
    ds_read_b64 v[146:147], v85 offset:8704
    ds_read_b64 v[148:149], v85 offset:9216
    ds_read_b64 v[150:151], v85 offset:9728
    ds_read_b64 v[152:153], v85 offset:10240
    ds_read_b64 v[154:155], v85 offset:10752
    ds_read_b64 v[156:157], v85 offset:11264
    ds_read_b64 v[158:159], v85 offset:11776
    ds_read_b64 v[160:161], v85 offset:12288
    ds_read_b64 v[162:163], v85 offset:12800
    ds_read_b64 v[164:165], v85 offset:13312
    ds_read_b64 v[166:167], v85 offset:13824
    ds_read_b64 v[168:169], v85 offset:14336
    ds_read_b64 v[170:171], v85 offset:14848
    ds_read_b64 v[172:173], v85 offset:15360
    ds_read_b64 v[174:175], v85 offset:15872
    ds_read_b64 v[176:177], v85 offset:16384
    ds_read_b64 v[178:179], v85 offset:16896
    ds_read_b64 v[180:181], v85 offset:17408
    ds_read_b64 v[182:183], v85 offset:17920
    ds_read_b64 v[184:185], v85 offset:18432
    ds_read_b64 v[186:187], v85 offset:18944
    ds_read_b64 v[188:189], v85 offset:19456
    ds_read_b64 v[190:191], v85 offset:19968
    s_waitcnt lgkmcnt(15)
    v_pk_add_f32 v[112:113], v[112:113], v[132:133]
    v_pk_add_f32 v[114:115], v[114:115], v[134:135]
    v_pk_add_f32 v[116:117], v[116:117], v[136:137]
    v_pk_add_f32 v[118:119], v[118:119], v[138:139]
    v_pk_add_f32 v[120:121], v[120:121], v[140:141]
    v_pk_add_f32 v[122:123], v[122:123], v[142:143]
    v_pk_add_f32 v[124:125], v[124:125], v[144:145]
    v_pk_add_f32 v[126:127], v[126:127], v[146:147]
    v_pk_add_f32 v[128:129], v[128:129], v[148:149]
    v_pk_add_f32 v[130:131], v[130:131], v[150:151]
    v_dot2_f32_bf16 v112, v18, s92, v112
    v_dot2_f32_bf16 v113, v18, s93, v113
    v_dot2_f32_bf16 v114, v19, s92, v114
    v_dot2_f32_bf16 v115, v19, s93, v115
    v_dot2_f32_bf16 v116, v20, s92, v116
    v_dot2_f32_bf16 v117, v20, s93, v117
    v_dot2_f32_bf16 v118, v21, s92, v118
    v_dot2_f32_bf16 v119, v21, s93, v119
    v_dot2_f32_bf16 v120, v22, s92, v120
    v_dot2_f32_bf16 v121, v22, s93, v121
    v_dot2_f32_bf16 v122, v23, s92, v122
    v_dot2_f32_bf16 v123, v23, s93, v123
    v_dot2_f32_bf16 v124, v24, s92, v124
    v_dot2_f32_bf16 v125, v24, s93, v125
    v_dot2_f32_bf16 v126, v25, s92, v126
    v_dot2_f32_bf16 v127, v25, s93, v127
    v_dot2_f32_bf16 v128, v26, s92, v128
    v_dot2_f32_bf16 v129, v26, s93, v129
    v_dot2_f32_bf16 v130, v27, s92, v130
    v_dot2_f32_bf16 v131, v27, s93, v131
    s_waitcnt lgkmcnt(9)
    v_pk_add_f32 v[152:153], v[152:153], v[172:173]
    s_waitcnt lgkmcnt(8)
    v_pk_add_f32 v[154:155], v[154:155], v[174:175]
    s_waitcnt lgkmcnt(7)
    v_pk_add_f32 v[156:157], v[156:157], v[176:177]
    s_waitcnt lgkmcnt(6)
    v_pk_add_f32 v[158:159], v[158:159], v[178:179]
    s_waitcnt lgkmcnt(5)
    v_pk_add_f32 v[160:161], v[160:161], v[180:181]
    s_waitcnt lgkmcnt(4)
    v_pk_add_f32 v[162:163], v[162:163], v[182:183]
    s_waitcnt lgkmcnt(3)
    v_pk_add_f32 v[164:165], v[164:165], v[184:185]
    s_waitcnt lgkmcnt(2)
    v_pk_add_f32 v[166:167], v[166:167], v[186:187]
    s_waitcnt lgkmcnt(1)
    v_pk_add_f32 v[168:169], v[168:169], v[188:189]
    s_waitcnt lgkmcnt(0)
    v_pk_add_f32 v[170:171], v[170:171], v[190:191]
    v_pk_add_f32 v[112:113], v[112:113], v[152:153]
    v_pk_add_f32 v[114:115], v[114:115], v[154:155]
    v_pk_add_f32 v[116:117], v[116:117], v[156:157]
    v_pk_add_f32 v[118:119], v[118:119], v[158:159]
    v_pk_add_f32 v[120:121], v[120:121], v[160:161]
    v_pk_add_f32 v[122:123], v[122:123], v[162:163]
    v_pk_add_f32 v[124:125], v[124:125], v[164:165]
    v_pk_add_f32 v[126:127], v[126:127], v[166:167]
    v_pk_add_f32 v[128:129], v[128:129], v[168:169]
    v_pk_add_f32 v[130:131], v[130:131], v[170:171]
    v_cvt_pk_bf16_f32 v40, v112, v113
    v_cvt_pk_bf16_f32 v41, v114, v115
    v_cvt_pk_bf16_f32 v42, v116, v117
    v_cvt_pk_bf16_f32 v43, v118, v119
    v_cvt_pk_bf16_f32 v44, v120, v121
    v_cvt_pk_bf16_f32 v45, v122, v123
    v_cvt_pk_bf16_f32 v46, v124, v125
    v_cvt_pk_bf16_f32 v47, v126, v127
    v_cvt_pk_bf16_f32 v48, v128, v129
    v_cvt_pk_bf16_f32 v49, v130, v131
    ds_write_b64 v86, v[40:41] offset:0
    ds_write_b64 v86, v[42:43] offset:8
    ds_write_b64 v86, v[44:45] offset:16
    ds_write_b64 v86, v[46:47] offset:24
    ds_write_b64 v86, v[48:49] offset:32
    ds_read_b128 v[52:55], v87 offset:0
    ds_read_b128 v[56:59], v87 offset:1024
    ds_read_b128 v[60:63], v87 offset:2048
    s_waitcnt lgkmcnt(2)
    buffer_store_dwordx4 v[52:55], v88, s[56:59], s98 offen sc1
    s_waitcnt lgkmcnt(1)
    buffer_store_dwordx4 v[56:59], v89, s[56:59], s98 offen sc1
    s_waitcnt lgkmcnt(0)
    buffer_store_dwordx4 v[60:63], v90, s[56:59], s98 offen sc1
    s_or_b32 s72, s64, s65
    s_cmp_lg_u32 s72, 0
    s_cbranch_scc1 L_end
    buffer_store_dwordx2 v[8:9], v5, s[36:39], 0 offen
L_end:
    s_endpgm
.section .rodata,"a"
.p2align 6
.amdhsa_kernel sequential_preLN__linear_kernel_hedgehog__glu_gated_geglu__prompt_kernel
  .amdhsa_next_free_vgpr 512
  .amdhsa_next_free_sgpr 102
  .amdhsa_accum_offset 256
  .amdhsa_group_segment_fixed_size 0
  .amdhsa_kernarg_size 88
  .amdhsa_user_sgpr_count 2
  .amdhsa_user_sgpr_kernarg_segment_ptr 1
  .amdhsa_system_sgpr_workgroup_id_x 1
.end_amdhsa_kernel
```
